```python
import torch

def _softmax(x, axis=-1):
    return torch.softmax(x, dim=axis)
def _gelu(x):
    return torch.nn.functional.gelu(x, approximate="tanh")
def _silu(x):
    return torch.nn.functional.silu(x)
def _sigmoid(x):
    return torch.sigmoid(x)
def _layernorm(x, axis=-1, eps=1e-5):
    m = x.mean(dim=axis, keepdim=True)
    v = x.var(dim=axis, keepdim=True, unbiased=False)
    return (x - m) / torch.sqrt(v + eps)
def _scatter_add(tgt, idx, src, axis=0):
    return tgt.clone().index_add_(axis, idx, src)
def _segment_sum(src, seg, n):
    out = torch.zeros((n,) + src.shape[1:], dtype=src.dtype)
    return out.index_add_(0, seg, src)
def _pad(x, pw):
    flat = tuple(v for pair in reversed(pw) for v in pair)
    return torch.nn.functional.pad(x, flat)

kernel_name = 'gated_mix__mha_block__mha_block__prompt'

def setup_inputs():

    _w = (lambda a: (lambda t: t.to(torch.bfloat16) if t.is_floating_point() else t)(torch.as_tensor(a)))
    def _A_setup():
        B, S, D, H = 1, 2048, 512, 32
        return {
            "x": _w((lambda *s: torch.randn(*s, dtype=torch.bfloat16) * 0.05)(B, S, D)),
            "wqkv": _w((lambda *s: torch.randn(*s, dtype=torch.bfloat16) * 0.8)(D, 3 * D)),
            "wo": _w((lambda *s: torch.randn(*s, dtype=torch.bfloat16) * 0.05)(D, D)),
        }
    _A_in = _A_setup()

    def _B_setup():
        B, S, D, H = 1, 2048, 512, 32
        return {
            "x": _w((lambda *s: torch.randn(*s, dtype=torch.bfloat16) * 0.05)(B, S, D)),
            "wqkv": _w((lambda *s: torch.randn(*s, dtype=torch.bfloat16) * 0.8)(D, 3 * D)),
            "wo": _w((lambda *s: torch.randn(*s, dtype=torch.bfloat16) * 0.05)(D, D)),
        }
    _B_in = _B_setup()

    return {
        "A_x": _A_in["x"],
        "A_wqkv": _A_in["wqkv"],
        "A_wo": _A_in["wo"],
        "B_x": _B_in["x"],
        "B_wqkv": _B_in["wqkv"],
        "B_wo": _B_in["wo"],
        "gate_w": _w((lambda *s: torch.randn(*s, dtype=torch.bfloat16) * 0.05)(512) * 16.0),
    }

def reference(A_x, A_wqkv, A_wo, B_x, B_wqkv, B_wo, gate_w):
    def _A_ref(x, wqkv, wo):
        B, S, D = x.shape
        H = 32
        Dh = D // H
        qkv = (lambda x, *d: x.permute(*d))((x @ wqkv).reshape(B, S, 3, H, Dh), 2, 0, 3, 1, 4)
        q, k, v = qkv[0], qkv[1], qkv[2]
        scores = torch.einsum("bhqd,bhkd->bhqk", q, k) * (Dh ** -0.5)
        p = _softmax(scores, axis=-1)
        o = torch.einsum("bhqk,bhkd->bhqd", p, v)
        return (lambda x, *d: x.permute(*d))(o, 0, 2, 1, 3).reshape(B, S, D) @ wo

    def _B_ref(x, wqkv, wo):
        B, S, D = x.shape
        H = 32
        Dh = D // H
        qkv = (lambda x, *d: x.permute(*d))((x @ wqkv).reshape(B, S, 3, H, Dh), 2, 0, 3, 1, 4)
        q, k, v = qkv[0], qkv[1], qkv[2]
        scores = torch.einsum("bhqd,bhkd->bhqk", q, k) * (Dh ** -0.5)
        p = _softmax(scores, axis=-1)
        o = torch.einsum("bhqk,bhkd->bhqd", p, v)
        return (lambda x, *d: x.permute(*d))(o, 0, 2, 1, 3).reshape(B, S, D) @ wo

    x = A_x
    g = _sigmoid((x * gate_w).sum(-1, keepdims=True))
    a = _A_ref(x, A_wqkv, A_wo)
    b = _B_ref(x, B_wqkv, B_wo)
    return g * a + (1 - g) * b
```

```asm
; @launch grid=(256,1,1) block=(512,1,1) lds=163840
.amdgcn_target "amdgcn-amd-amdhsa--gfx950"
.text
.globl gated_mix__mha_block__mha_block__prompt_kernel
.p2align 8
.type gated_mix__mha_block__mha_block__prompt_kernel,@function
gated_mix__mha_block__mha_block__prompt_kernel:

  s_cmp_ge_u32 s2, 256
  s_cbranch_scc1 gated_mix__mha_block__mha_block__prompt_kernel_end
  s_load_dwordx2 s[24:25], s[0:1], 0
  s_load_dwordx2 s[26:27], s[0:1], 8
  s_load_dwordx2 s[28:29], s[0:1], 16
  s_load_dwordx2 s[30:31], s[0:1], 32
  s_load_dwordx2 s[88:89], s[0:1], 40
  s_load_dwordx2 s[32:33], s[0:1], 48
  s_load_dwordx2 s[90:91], s[0:1], 56
  s_load_dwordx2 s[92:93], s[0:1], 64
  s_load_dwordx2 s[34:35], s[0:1], 72
  v_lshrrev_b32 v2, 6, v0
  v_and_b32 v1, 63, v0
  s_and_b32 s36, s2, 7
  s_lshr_b32 s37, s2, 3
  s_and_b32 s23, s36, 1
  s_lshl_b32 s23, s23, 2
  s_and_b32 s38, s37, 3
  s_add_u32 s23, s23, s38
  s_lshr_b32 s36, s36, 1
  s_lshl_b32 s36, s36, 3
  s_lshr_b32 s37, s37, 2
  s_add_u32 s95, s36, s37
  s_lshr_b32 s21, s95, 4
  s_and_b32 s22, s95, 15
  v_readfirstlane_b32 s20, v2
  s_nop 3
  s_cmp_lt_u32 s20, 4
  s_cbranch_scc1 gated_mix__mha_block__mha_block__prompt_kernel_p1_consumer
  v_lshlrev_b32 v6, 4, v1
  s_sub_u32 s47, s20, 4
  v_lshrrev_b32 v2, 3, v1
  v_lshlrev_b32 v3, 10, v2
  v_and_b32 v4, 7, v1
  v_lshrrev_b32 v5, 4, v1
  v_xor_b32 v5, v4, v5
  v_lshl_add_u32 v7, v5, 4, v3
  v_xor_b32 v5, 4, v5
  v_lshl_add_u32 v8, v5, 4, v3
  v_lshrrev_b32 v2, 2, v1
  v_mul_u32_u24 v3, 3072, v2
  v_and_b32 v4, 3, v1
  v_lshrrev_b32 v5, 5, v1
  v_lshlrev_b32 v5, 1, v5
  v_xor_b32 v4, v4, v5
  v_lshl_add_u32 v9, v4, 4, v3
  s_lshl_b32 s40, s23, 18
  s_lshl_b32 s36, s47, 16
  s_add_u32 s40, s40, s36
  s_lshl_b32 s42, s47, 13
  s_lshl_b32 s41, s22, 6
  s_lshl_b32 s56, s23, 1
  s_add_u32 s56, s56, s95
  s_mul_i32 s36, s47, 3
  s_add_u32 s36, s36, 0
  s_lshr_b32 s37, s36, 2
  s_and_b32 s36, s36, 3
  s_mul_i32 s38, s36, 49152
  s_lshl_b32 s39, s37, 10
  s_add_u32 s38, s38, s39
  s_add_u32 s48, s38, s41
  s_lshl_b32 s37, s37, 12
  s_lshl_b32 s36, s36, 10
  s_add_u32 s37, s37, s36
  s_add_u32 s51, s37, 32768
  s_mul_i32 s36, s47, 3
  s_add_u32 s36, s36, 1
  s_lshr_b32 s37, s36, 2
  s_and_b32 s36, s36, 3
  s_mul_i32 s38, s36, 49152
  s_lshl_b32 s39, s37, 10
  s_add_u32 s38, s38, s39
  s_add_u32 s49, s38, s41
  s_lshl_b32 s37, s37, 12
  s_lshl_b32 s36, s36, 10
  s_add_u32 s37, s37, s36
  s_add_u32 s52, s37, 32768
  s_mul_i32 s36, s47, 3
  s_add_u32 s36, s36, 2
  s_lshr_b32 s37, s36, 2
  s_and_b32 s36, s36, 3
  s_mul_i32 s38, s36, 49152
  s_lshl_b32 s39, s37, 10
  s_add_u32 s38, s38, s39
  s_add_u32 s50, s38, s41
  s_lshl_b32 s37, s37, 12
  s_lshl_b32 s36, s36, 10
  s_add_u32 s37, s37, s36
  s_add_u32 s53, s37, 32768
  s_waitcnt lgkmcnt(0)
  s_cmp_eq_u32 s21, 0
  s_cselect_b32 s38, s26, s30
  s_cselect_b32 s39, s27, s31
  s_mov_b32 s4, s24
  s_and_b32 s5, s25, 0xffff
  s_mov_b32 s6, 2097152
  s_mov_b32 s7, 0x20000
  s_mov_b32 s8, s38
  s_and_b32 s9, s39, 0xffff
  s_mov_b32 s10, 1572864
  s_mov_b32 s11, 0x20000
  s_mov_b32 s12, s34
  s_and_b32 s13, s35, 0xffff
  s_mov_b32 s14, 268435456
  s_mov_b32 s15, 0x20000
  s_mov_b32 s16, s32
  s_and_b32 s17, s33, 0xffff
  s_mov_b32 s18, 1024
  s_mov_b32 s19, 0x20000
  s_mov_b32 s96, s92
  s_and_b32 s97, s93, 0xffff
  s_mov_b32 s98, 256
  s_mov_b32 s99, 0x20000
  s_add_u32 s57, s56, 0
  s_and_b32 s57, s57, 7
  s_mul_i32 s58, s57, 196608
  s_lshl_b32 s57, s57, 7
  s_add_u32 m0, s51, 0
  s_add_u32 s44, s48, s58
  buffer_load_dwordx4 v9, s[8:11], s44 offen lds
  s_add_u32 m0, s52, 0
  s_add_u32 s44, s49, s58
  buffer_load_dwordx4 v9, s[8:11], s44 offen lds
  s_add_u32 m0, s53, 0
  s_add_u32 s44, s50, s58
  buffer_load_dwordx4 v9, s[8:11], s44 offen lds
  s_add_u32 s59, s57, s40
  s_add_u32 m0, s42, 0
  s_add_u32 s44, s59, 0
  buffer_load_dwordx4 v7, s[4:7], s44 offen lds
  s_add_u32 m0, s42, 1024
  s_add_u32 s44, s59, 8192
  buffer_load_dwordx4 v8, s[4:7], s44 offen lds
  s_add_u32 m0, s42, 2048
  s_add_u32 s44, s59, 16384
  buffer_load_dwordx4 v7, s[4:7], s44 offen lds
  s_add_u32 m0, s42, 3072
  s_add_u32 s44, s59, 24576
  buffer_load_dwordx4 v8, s[4:7], s44 offen lds
  s_add_u32 m0, s42, 4096
  s_add_u32 s44, s59, 32768
  buffer_load_dwordx4 v7, s[4:7], s44 offen lds
  s_add_u32 m0, s42, 5120
  s_add_u32 s44, s59, 40960
  buffer_load_dwordx4 v8, s[4:7], s44 offen lds
  s_add_u32 m0, s42, 6144
  s_add_u32 s44, s59, 49152
  buffer_load_dwordx4 v7, s[4:7], s44 offen lds
  s_add_u32 m0, s42, 7168
  s_add_u32 s44, s59, 57344
  buffer_load_dwordx4 v8, s[4:7], s44 offen lds
  s_mov_b32 m0, 135168
  s_mov_b32 s44, 0
  buffer_load_dwordx4 v6, s[16:19], s44 offen lds
  s_add_u32 s57, s56, 1
  s_and_b32 s57, s57, 7
  s_mul_i32 s58, s57, 196608
  s_lshl_b32 s57, s57, 7
  s_add_u32 m0, s51, 45056
  s_add_u32 s44, s48, s58
  buffer_load_dwordx4 v9, s[8:11], s44 offen lds
  s_add_u32 m0, s52, 45056
  s_add_u32 s44, s49, s58
  buffer_load_dwordx4 v9, s[8:11], s44 offen lds
  s_add_u32 m0, s53, 45056
  s_add_u32 s44, s50, s58
  buffer_load_dwordx4 v9, s[8:11], s44 offen lds
  s_add_u32 s59, s57, s40
  s_add_u32 m0, s42, 45056
  s_add_u32 s44, s59, 0
  buffer_load_dwordx4 v7, s[4:7], s44 offen lds
  s_add_u32 m0, s42, 46080
  s_add_u32 s44, s59, 8192
  buffer_load_dwordx4 v8, s[4:7], s44 offen lds
  s_add_u32 m0, s42, 47104
  s_add_u32 s44, s59, 16384
  buffer_load_dwordx4 v7, s[4:7], s44 offen lds
  s_add_u32 m0, s42, 48128
  s_add_u32 s44, s59, 24576
  buffer_load_dwordx4 v8, s[4:7], s44 offen lds
  s_add_u32 m0, s42, 49152
  s_add_u32 s44, s59, 32768
  buffer_load_dwordx4 v7, s[4:7], s44 offen lds
  s_add_u32 m0, s42, 50176
  s_add_u32 s44, s59, 40960
  buffer_load_dwordx4 v8, s[4:7], s44 offen lds
  s_add_u32 m0, s42, 51200
  s_add_u32 s44, s59, 49152
  buffer_load_dwordx4 v7, s[4:7], s44 offen lds
  s_add_u32 m0, s42, 52224
  s_add_u32 s44, s59, 57344
  buffer_load_dwordx4 v8, s[4:7], s44 offen lds
  s_add_u32 s57, s56, 2
  s_and_b32 s57, s57, 7
  s_mul_i32 s58, s57, 196608
  s_lshl_b32 s57, s57, 7
  s_add_u32 m0, s51, 90112
  s_add_u32 s44, s48, s58
  buffer_load_dwordx4 v9, s[8:11], s44 offen lds
  s_add_u32 m0, s52, 90112
  s_add_u32 s44, s49, s58
  buffer_load_dwordx4 v9, s[8:11], s44 offen lds
  s_add_u32 m0, s53, 90112
  s_add_u32 s44, s50, s58
  buffer_load_dwordx4 v9, s[8:11], s44 offen lds
  s_add_u32 s59, s57, s40
  s_add_u32 m0, s42, 90112
  s_add_u32 s44, s59, 0
  buffer_load_dwordx4 v7, s[4:7], s44 offen lds
  s_add_u32 m0, s42, 91136
  s_add_u32 s44, s59, 8192
  buffer_load_dwordx4 v8, s[4:7], s44 offen lds
  s_add_u32 m0, s42, 92160
  s_add_u32 s44, s59, 16384
  buffer_load_dwordx4 v7, s[4:7], s44 offen lds
  s_add_u32 m0, s42, 93184
  s_add_u32 s44, s59, 24576
  buffer_load_dwordx4 v8, s[4:7], s44 offen lds
  s_add_u32 m0, s42, 94208
  s_add_u32 s44, s59, 32768
  buffer_load_dwordx4 v7, s[4:7], s44 offen lds
  s_add_u32 m0, s42, 95232
  s_add_u32 s44, s59, 40960
  buffer_load_dwordx4 v8, s[4:7], s44 offen lds
  s_add_u32 m0, s42, 96256
  s_add_u32 s44, s59, 49152
  buffer_load_dwordx4 v7, s[4:7], s44 offen lds
  s_add_u32 m0, s42, 97280
  s_add_u32 s44, s59, 57344
  buffer_load_dwordx4 v8, s[4:7], s44 offen lds
  s_lshl_b32 s36, s95, 3
  v_lshrrev_b32 v2, 3, v1
  v_add_u32 v2, s36, v2
  v_bfe_u32 v3, v2, 1, 3
  v_and_b32 v4, 7, v1
  v_xor_b32 v3, v3, v4
  v_lshlrev_b32 v2, 7, v2
  v_lshl_add_u32 v10, v3, 4, v2
  v_lshlrev_b32 v13, 4, v4
  v_add_u32 v13, 135168, v13
  v_mov_b32 v14, 0
  v_add_u32 v11, 45056, v10
  v_add_u32 v12, 90112, v10
  s_cmp_eq_u32 s2, 0
  s_cselect_b32 s54, 1, 0
  s_cmp_eq_u32 s20, 7
  s_cselect_b32 s54, s54, 0
  s_waitcnt vmcnt(22)
  s_barrier
  s_cmp_eq_u32 s54, 0
  s_cbranch_scc1 gated_mix__mha_block__mha_block__prompt_kernel_noep
  v_mov_b32 v5, 0
  s_mov_b32 s44, 22216704
  buffer_load_dword v15, v5, s[12:15], s44 offen sc1
gated_mix__mha_block__mha_block__prompt_kernel_noep:
  s_cmp_lg_u32 s20, 4
  s_cbranch_scc1 gated_mix__mha_block__mha_block__prompt_kernel_ng0
  s_add_u32 s57, s56, 0
  s_and_b32 s57, s57, 7
  s_mul_i32 s58, s57, 196608
  s_lshl_b32 s57, s57, 7
  v_add_u32 v2, s57, v13
  ds_read_b128 v[16:19], v10
  ds_read_b128 v[20:23], v2
  s_waitcnt lgkmcnt(0)
  v_dot2c_f32_bf16 v14, v16, v20
  v_dot2c_f32_bf16 v14, v17, v21
  v_dot2c_f32_bf16 v14, v18, v22
  v_dot2c_f32_bf16 v14, v19, v23
gated_mix__mha_block__mha_block__prompt_kernel_ng0:
  s_waitcnt vmcnt(11)
  s_barrier
  s_add_u32 s57, s56, 3
  s_and_b32 s57, s57, 7
  s_mul_i32 s58, s57, 196608
  s_lshl_b32 s57, s57, 7
  s_add_u32 m0, s51, 0
  s_add_u32 s44, s48, s58
  buffer_load_dwordx4 v9, s[8:11], s44 offen lds
  s_add_u32 m0, s52, 0
  s_add_u32 s44, s49, s58
  buffer_load_dwordx4 v9, s[8:11], s44 offen lds
  s_add_u32 m0, s53, 0
  s_add_u32 s44, s50, s58
  buffer_load_dwordx4 v9, s[8:11], s44 offen lds
  s_add_u32 s59, s57, s40
  s_add_u32 m0, s42, 0
  s_add_u32 s44, s59, 0
  buffer_load_dwordx4 v7, s[4:7], s44 offen lds
  s_add_u32 m0, s42, 1024
  s_add_u32 s44, s59, 8192
  buffer_load_dwordx4 v8, s[4:7], s44 offen lds
  s_add_u32 m0, s42, 2048
  s_add_u32 s44, s59, 16384
  buffer_load_dwordx4 v7, s[4:7], s44 offen lds
  s_add_u32 m0, s42, 3072
  s_add_u32 s44, s59, 24576
  buffer_load_dwordx4 v8, s[4:7], s44 offen lds
  s_add_u32 m0, s42, 4096
  s_add_u32 s44, s59, 32768
  buffer_load_dwordx4 v7, s[4:7], s44 offen lds
  s_add_u32 m0, s42, 5120
  s_add_u32 s44, s59, 40960
  buffer_load_dwordx4 v8, s[4:7], s44 offen lds
  s_add_u32 m0, s42, 6144
  s_add_u32 s44, s59, 49152
  buffer_load_dwordx4 v7, s[4:7], s44 offen lds
  s_add_u32 m0, s42, 7168
  s_add_u32 s44, s59, 57344
  buffer_load_dwordx4 v8, s[4:7], s44 offen lds
  s_cmp_lg_u32 s20, 4
  s_cbranch_scc1 gated_mix__mha_block__mha_block__prompt_kernel_ng1
  s_add_u32 s57, s56, 1
  s_and_b32 s57, s57, 7
  s_mul_i32 s58, s57, 196608
  s_lshl_b32 s57, s57, 7
  v_add_u32 v2, s57, v13
  ds_read_b128 v[16:19], v11
  ds_read_b128 v[20:23], v2
  s_waitcnt lgkmcnt(0)
  v_dot2c_f32_bf16 v14, v16, v20
  v_dot2c_f32_bf16 v14, v17, v21
  v_dot2c_f32_bf16 v14, v18, v22
  v_dot2c_f32_bf16 v14, v19, v23
gated_mix__mha_block__mha_block__prompt_kernel_ng1:
  s_waitcnt vmcnt(11)
  s_barrier
  s_add_u32 s57, s56, 4
  s_and_b32 s57, s57, 7
  s_mul_i32 s58, s57, 196608
  s_lshl_b32 s57, s57, 7
  s_add_u32 m0, s51, 45056
  s_add_u32 s44, s48, s58
  buffer_load_dwordx4 v9, s[8:11], s44 offen lds
  s_add_u32 m0, s52, 45056
  s_add_u32 s44, s49, s58
  buffer_load_dwordx4 v9, s[8:11], s44 offen lds
  s_add_u32 m0, s53, 45056
  s_add_u32 s44, s50, s58
  buffer_load_dwordx4 v9, s[8:11], s44 offen lds
  s_add_u32 s59, s57, s40
  s_add_u32 m0, s42, 45056
  s_add_u32 s44, s59, 0
  buffer_load_dwordx4 v7, s[4:7], s44 offen lds
  s_add_u32 m0, s42, 46080
  s_add_u32 s44, s59, 8192
  buffer_load_dwordx4 v8, s[4:7], s44 offen lds
  s_add_u32 m0, s42, 47104
  s_add_u32 s44, s59, 16384
  buffer_load_dwordx4 v7, s[4:7], s44 offen lds
  s_add_u32 m0, s42, 48128
  s_add_u32 s44, s59, 24576
  buffer_load_dwordx4 v8, s[4:7], s44 offen lds
  s_add_u32 m0, s42, 49152
  s_add_u32 s44, s59, 32768
  buffer_load_dwordx4 v7, s[4:7], s44 offen lds
  s_add_u32 m0, s42, 50176
  s_add_u32 s44, s59, 40960
  buffer_load_dwordx4 v8, s[4:7], s44 offen lds
  s_add_u32 m0, s42, 51200
  s_add_u32 s44, s59, 49152
  buffer_load_dwordx4 v7, s[4:7], s44 offen lds
  s_add_u32 m0, s42, 52224
  s_add_u32 s44, s59, 57344
  buffer_load_dwordx4 v8, s[4:7], s44 offen lds
  s_cmp_eq_u32 s54, 0
  s_cbranch_scc1 gated_mix__mha_block__mha_block__prompt_kernel_nononce
  v_add_u32 v24, 1, v15
  v_mov_b32 v25, 1
  v_mov_b32 v5, 0
  s_mov_b32 s44, 22216704
  s_mov_b64 exec, 1
  buffer_store_dword v24, v5, s[12:15], s44 offen sc1
  buffer_store_dwordx2 v[24:25], v5, s[96:99], 0 offen sc1
  s_mov_b64 exec, -1
  s_nop 1
gated_mix__mha_block__mha_block__prompt_kernel_nononce:
  s_cmp_lg_u32 s20, 4
  s_cbranch_scc1 gated_mix__mha_block__mha_block__prompt_kernel_ng2
  s_add_u32 s57, s56, 2
  s_and_b32 s57, s57, 7
  s_mul_i32 s58, s57, 196608
  s_lshl_b32 s57, s57, 7
  v_add_u32 v2, s57, v13
  ds_read_b128 v[16:19], v12
  ds_read_b128 v[20:23], v2
  s_waitcnt lgkmcnt(0)
  v_dot2c_f32_bf16 v14, v16, v20
  v_dot2c_f32_bf16 v14, v17, v21
  v_dot2c_f32_bf16 v14, v18, v22
  v_dot2c_f32_bf16 v14, v19, v23
gated_mix__mha_block__mha_block__prompt_kernel_ng2:
  s_waitcnt vmcnt(11)
  s_barrier
  s_add_u32 s57, s56, 5
  s_and_b32 s57, s57, 7
  s_mul_i32 s58, s57, 196608
  s_lshl_b32 s57, s57, 7
  s_add_u32 m0, s51, 90112
  s_add_u32 s44, s48, s58
  buffer_load_dwordx4 v9, s[8:11], s44 offen lds
  s_add_u32 m0, s52, 90112
  s_add_u32 s44, s49, s58
  buffer_load_dwordx4 v9, s[8:11], s44 offen lds
  s_add_u32 m0, s53, 90112
  s_add_u32 s44, s50, s58
  buffer_load_dwordx4 v9, s[8:11], s44 offen lds
  s_add_u32 s59, s57, s40
  s_add_u32 m0, s42, 90112
  s_add_u32 s44, s59, 0
  buffer_load_dwordx4 v7, s[4:7], s44 offen lds
  s_add_u32 m0, s42, 91136
  s_add_u32 s44, s59, 8192
  buffer_load_dwordx4 v8, s[4:7], s44 offen lds
  s_add_u32 m0, s42, 92160
  s_add_u32 s44, s59, 16384
  buffer_load_dwordx4 v7, s[4:7], s44 offen lds
  s_add_u32 m0, s42, 93184
  s_add_u32 s44, s59, 24576
  buffer_load_dwordx4 v8, s[4:7], s44 offen lds
  s_add_u32 m0, s42, 94208
  s_add_u32 s44, s59, 32768
  buffer_load_dwordx4 v7, s[4:7], s44 offen lds
  s_add_u32 m0, s42, 95232
  s_add_u32 s44, s59, 40960
  buffer_load_dwordx4 v8, s[4:7], s44 offen lds
  s_add_u32 m0, s42, 96256
  s_add_u32 s44, s59, 49152
  buffer_load_dwordx4 v7, s[4:7], s44 offen lds
  s_add_u32 m0, s42, 97280
  s_add_u32 s44, s59, 57344
  buffer_load_dwordx4 v8, s[4:7], s44 offen lds
  s_cmp_lg_u32 s20, 4
  s_cbranch_scc1 gated_mix__mha_block__mha_block__prompt_kernel_ng3
  s_add_u32 s57, s56, 3
  s_and_b32 s57, s57, 7
  s_mul_i32 s58, s57, 196608
  s_lshl_b32 s57, s57, 7
  v_add_u32 v2, s57, v13
  ds_read_b128 v[16:19], v10
  ds_read_b128 v[20:23], v2
  s_waitcnt lgkmcnt(0)
  v_dot2c_f32_bf16 v14, v16, v20
  v_dot2c_f32_bf16 v14, v17, v21
  v_dot2c_f32_bf16 v14, v18, v22
  v_dot2c_f32_bf16 v14, v19, v23
gated_mix__mha_block__mha_block__prompt_kernel_ng3:
  s_waitcnt vmcnt(11)
  s_barrier
  s_add_u32 s57, s56, 6
  s_and_b32 s57, s57, 7
  s_mul_i32 s58, s57, 196608
  s_lshl_b32 s57, s57, 7
  s_add_u32 m0, s51, 0
  s_add_u32 s44, s48, s58
  buffer_load_dwordx4 v9, s[8:11], s44 offen lds
  s_add_u32 m0, s52, 0
  s_add_u32 s44, s49, s58
  buffer_load_dwordx4 v9, s[8:11], s44 offen lds
  s_add_u32 m0, s53, 0
  s_add_u32 s44, s50, s58
  buffer_load_dwordx4 v9, s[8:11], s44 offen lds
  s_add_u32 s59, s57, s40
  s_add_u32 m0, s42, 0
  s_add_u32 s44, s59, 0
  buffer_load_dwordx4 v7, s[4:7], s44 offen lds
  s_add_u32 m0, s42, 1024
  s_add_u32 s44, s59, 8192
  buffer_load_dwordx4 v8, s[4:7], s44 offen lds
  s_add_u32 m0, s42, 2048
  s_add_u32 s44, s59, 16384
  buffer_load_dwordx4 v7, s[4:7], s44 offen lds
  s_add_u32 m0, s42, 3072
  s_add_u32 s44, s59, 24576
  buffer_load_dwordx4 v8, s[4:7], s44 offen lds
  s_add_u32 m0, s42, 4096
  s_add_u32 s44, s59, 32768
  buffer_load_dwordx4 v7, s[4:7], s44 offen lds
  s_add_u32 m0, s42, 5120
  s_add_u32 s44, s59, 40960
  buffer_load_dwordx4 v8, s[4:7], s44 offen lds
  s_add_u32 m0, s42, 6144
  s_add_u32 s44, s59, 49152
  buffer_load_dwordx4 v7, s[4:7], s44 offen lds
  s_add_u32 m0, s42, 7168
  s_add_u32 s44, s59, 57344
  buffer_load_dwordx4 v8, s[4:7], s44 offen lds
  s_cmp_lg_u32 s20, 4
  s_cbranch_scc1 gated_mix__mha_block__mha_block__prompt_kernel_ng4
  s_add_u32 s57, s56, 4
  s_and_b32 s57, s57, 7
  s_mul_i32 s58, s57, 196608
  s_lshl_b32 s57, s57, 7
  v_add_u32 v2, s57, v13
  ds_read_b128 v[16:19], v11
  ds_read_b128 v[20:23], v2
  s_waitcnt lgkmcnt(0)
  v_dot2c_f32_bf16 v14, v16, v20
  v_dot2c_f32_bf16 v14, v17, v21
  v_dot2c_f32_bf16 v14, v18, v22
  v_dot2c_f32_bf16 v14, v19, v23
gated_mix__mha_block__mha_block__prompt_kernel_ng4:
  s_waitcnt vmcnt(11)
  s_barrier
  s_add_u32 s57, s56, 7
  s_and_b32 s57, s57, 7
  s_mul_i32 s58, s57, 196608
  s_lshl_b32 s57, s57, 7
  s_add_u32 m0, s51, 45056
  s_add_u32 s44, s48, s58
  buffer_load_dwordx4 v9, s[8:11], s44 offen lds
  s_add_u32 m0, s52, 45056
  s_add_u32 s44, s49, s58
  buffer_load_dwordx4 v9, s[8:11], s44 offen lds
  s_add_u32 m0, s53, 45056
  s_add_u32 s44, s50, s58
  buffer_load_dwordx4 v9, s[8:11], s44 offen lds
  s_add_u32 s59, s57, s40
  s_add_u32 m0, s42, 45056
  s_add_u32 s44, s59, 0
  buffer_load_dwordx4 v7, s[4:7], s44 offen lds
  s_add_u32 m0, s42, 46080
  s_add_u32 s44, s59, 8192
  buffer_load_dwordx4 v8, s[4:7], s44 offen lds
  s_add_u32 m0, s42, 47104
  s_add_u32 s44, s59, 16384
  buffer_load_dwordx4 v7, s[4:7], s44 offen lds
  s_add_u32 m0, s42, 48128
  s_add_u32 s44, s59, 24576
  buffer_load_dwordx4 v8, s[4:7], s44 offen lds
  s_add_u32 m0, s42, 49152
  s_add_u32 s44, s59, 32768
  buffer_load_dwordx4 v7, s[4:7], s44 offen lds
  s_add_u32 m0, s42, 50176
  s_add_u32 s44, s59, 40960
  buffer_load_dwordx4 v8, s[4:7], s44 offen lds
  s_add_u32 m0, s42, 51200
  s_add_u32 s44, s59, 49152
  buffer_load_dwordx4 v7, s[4:7], s44 offen lds
  s_add_u32 m0, s42, 52224
  s_add_u32 s44, s59, 57344
  buffer_load_dwordx4 v8, s[4:7], s44 offen lds
  s_cmp_lg_u32 s20, 4
  s_cbranch_scc1 gated_mix__mha_block__mha_block__prompt_kernel_ng5
  s_add_u32 s57, s56, 5
  s_and_b32 s57, s57, 7
  s_mul_i32 s58, s57, 196608
  s_lshl_b32 s57, s57, 7
  v_add_u32 v2, s57, v13
  ds_read_b128 v[16:19], v12
  ds_read_b128 v[20:23], v2
  s_waitcnt lgkmcnt(0)
  v_dot2c_f32_bf16 v14, v16, v20
  v_dot2c_f32_bf16 v14, v17, v21
  v_dot2c_f32_bf16 v14, v18, v22
  v_dot2c_f32_bf16 v14, v19, v23
gated_mix__mha_block__mha_block__prompt_kernel_ng5:
  s_waitcnt vmcnt(11)
  s_barrier
  s_cmp_lg_u32 s20, 4
  s_cbranch_scc1 gated_mix__mha_block__mha_block__prompt_kernel_ng6
  s_add_u32 s57, s56, 6
  s_and_b32 s57, s57, 7
  s_mul_i32 s58, s57, 196608
  s_lshl_b32 s57, s57, 7
  v_add_u32 v2, s57, v13
  ds_read_b128 v[16:19], v10
  ds_read_b128 v[20:23], v2
  s_waitcnt lgkmcnt(0)
  v_dot2c_f32_bf16 v14, v16, v20
  v_dot2c_f32_bf16 v14, v17, v21
  v_dot2c_f32_bf16 v14, v18, v22
  v_dot2c_f32_bf16 v14, v19, v23
gated_mix__mha_block__mha_block__prompt_kernel_ng6:
  s_waitcnt vmcnt(0)
  s_barrier
  s_cmp_lg_u32 s20, 4
  s_cbranch_scc1 gated_mix__mha_block__mha_block__prompt_kernel_ng7
  s_add_u32 s57, s56, 7
  s_and_b32 s57, s57, 7
  s_mul_i32 s58, s57, 196608
  s_lshl_b32 s57, s57, 7
  v_add_u32 v2, s57, v13
  ds_read_b128 v[16:19], v11
  ds_read_b128 v[20:23], v2
  s_waitcnt lgkmcnt(0)
  v_dot2c_f32_bf16 v14, v16, v20
  v_dot2c_f32_bf16 v14, v17, v21
  v_dot2c_f32_bf16 v14, v18, v22
  v_dot2c_f32_bf16 v14, v19, v23
gated_mix__mha_block__mha_block__prompt_kernel_ng7:
  v_mov_b32 v4, 0
  buffer_load_dwordx2 v[250:251], v4, s[96:99], 0 offen sc1
  s_cmp_lg_u32 s20, 4
  s_cbranch_scc1 gated_mix__mha_block__mha_block__prompt_kernel_p1_end
  s_nop 1
  v_add_f32_dpp v14, v14, v14 quad_perm:[1,0,3,2] row_mask:0xf bank_mask:0xf
  s_nop 1
  v_add_f32_dpp v14, v14, v14 quad_perm:[2,3,0,1] row_mask:0xf bank_mask:0xf
  s_nop 1
  v_add_f32_dpp v14, v14, v14 row_half_mirror row_mask:0xf bank_mask:0xf
  s_mov_b32 s39, 0xbfb8aa3b
  s_nop 0
  v_cvt_pk_bf16_f32 v3, v14, v14
  v_lshlrev_b32 v3, 16, v3
  v_mul_f32 v3, s39, v3
  v_exp_f32 v3, v3
  s_nop 0
  v_add_f32 v3, 1.0, v3
  v_rcp_f32 v3, v3
  s_nop 0
  v_cvt_pk_bf16_f32 v3, v3, v3
  v_lshlrev_b32 v3, 16, v3
  v_lshrrev_b32 v2, 3, v1
  v_lshlrev_b32 v2, 2, v2
  s_lshl_b32 s36, s95, 5
  s_lshl_b32 s37, s23, 10
  s_add_u32 s36, s36, s37
  s_add_u32 s36, s36, 20971520
  v_and_b32 v4, 7, v1
  v_cmp_eq_u32 vcc, 0, v4
  s_and_saveexec_b64 s[54:55], vcc
  buffer_store_dword v3, v2, s[12:15], s36 offen sc1
  s_mov_b64 exec, s[54:55]
  s_branch gated_mix__mha_block__mha_block__prompt_kernel_p1_end
gated_mix__mha_block__mha_block__prompt_kernel_p1_consumer:
  v_lshlrev_b32 v6, 4, v1
  v_and_b32 v2, 15, v1
  v_lshlrev_b32 v3, 7, v2
  s_lshl_b32 s36, s20, 13
  v_add_u32 v3, s36, v3
  v_bfe_u32 v4, v1, 1, 3
  v_lshrrev_b32 v5, 4, v1
  v_xor_b32 v4, v4, v5
  v_xor_b32 v5, 0, v4
  v_lshl_add_u32 v7, v5, 4, v3
  v_add_u32 v9, 45056, v7
  v_add_u32 v11, 90112, v7
  v_xor_b32 v5, 4, v4
  v_lshl_add_u32 v8, v5, 4, v3
  v_add_u32 v10, 45056, v8
  v_add_u32 v12, 90112, v8
  v_lshrrev_b32 v2, 4, v1
  v_lshlrev_b32 v2, 3, v2
  v_bfe_u32 v3, v1, 2, 2
  v_add_u32 v2, v2, v3
  v_lshlrev_b32 v2, 6, v2
  v_and_b32 v4, 3, v1
  v_lshl_add_u32 v2, v4, 3, v2
  v_bfe_u32 v3, v1, 4, 1
  v_lshl_add_u32 v2, v3, 5, v2
  v_add_u32 v13, 32768, v2
  v_xor_b32 v14, 32, v13
  v_add_u32 v15, 45056, v13
  v_add_u32 v16, 45056, v14
  v_add_u32 v17, 90112, v13
  v_add_u32 v18, 90112, v14
  v_mov_b32 v248, v6
  v_bfe_u32 v2, v1, 4, 1
  v_lshlrev_b32 v2, 9, v2
  v_lshrrev_b32 v3, 5, v1
  v_lshl_add_u32 v2, v3, 8, v2
  v_and_b32 v3, 15, v1
  v_lshl_add_u32 v249, v3, 4, v2
  v_add_u32 v19, 65536, v249
  v_mov_b32 v20, 0
  v_mov_b32 v21, 0
  v_mov_b32 v22, 0
  v_mov_b32 v23, 0
  v_mov_b32 v24, 0
  v_mov_b32 v25, 0
  v_mov_b32 v26, 0
  v_mov_b32 v27, 0
  v_mov_b32 v28, 0
  v_mov_b32 v29, 0
  v_mov_b32 v30, 0
  v_mov_b32 v31, 0
  v_mov_b32 v32, 0
  v_mov_b32 v33, 0
  v_mov_b32 v34, 0
  v_mov_b32 v35, 0
  v_mov_b32 v36, 0
  v_mov_b32 v37, 0
  v_mov_b32 v38, 0
  v_mov_b32 v39, 0
  v_mov_b32 v40, 0
  v_mov_b32 v41, 0
  v_mov_b32 v42, 0
  v_mov_b32 v43, 0
  v_mov_b32 v44, 0
  v_mov_b32 v45, 0
  v_mov_b32 v46, 0
  v_mov_b32 v47, 0
  v_mov_b32 v48, 0
  v_mov_b32 v49, 0
  v_mov_b32 v50, 0
  v_mov_b32 v51, 0
  v_mov_b32 v52, 0
  v_mov_b32 v53, 0
  v_mov_b32 v54, 0
  v_mov_b32 v55, 0
  v_mov_b32 v56, 0
  v_mov_b32 v57, 0
  v_mov_b32 v58, 0
  v_mov_b32 v59, 0
  v_mov_b32 v60, 0
  v_mov_b32 v61, 0
  v_mov_b32 v62, 0
  v_mov_b32 v63, 0
  v_mov_b32 v64, 0
  v_mov_b32 v65, 0
  v_mov_b32 v66, 0
  v_mov_b32 v67, 0
  v_mov_b32 v68, 0
  v_mov_b32 v69, 0
  v_mov_b32 v70, 0
  v_mov_b32 v71, 0
  v_mov_b32 v72, 0
  v_mov_b32 v73, 0
  v_mov_b32 v74, 0
  v_mov_b32 v75, 0
  v_mov_b32 v76, 0
  v_mov_b32 v77, 0
  v_mov_b32 v78, 0
  v_mov_b32 v79, 0
  v_mov_b32 v80, 0
  v_mov_b32 v81, 0
  v_mov_b32 v82, 0
  v_mov_b32 v83, 0
  v_mov_b32 v84, 0
  v_mov_b32 v85, 0
  v_mov_b32 v86, 0
  v_mov_b32 v87, 0
  v_mov_b32 v88, 0
  v_mov_b32 v89, 0
  v_mov_b32 v90, 0
  v_mov_b32 v91, 0
  v_mov_b32 v92, 0
  v_mov_b32 v93, 0
  v_mov_b32 v94, 0
  v_mov_b32 v95, 0
  v_mov_b32 v96, 0
  v_mov_b32 v97, 0
  v_mov_b32 v98, 0
  v_mov_b32 v99, 0
  v_mov_b32 v100, 0
  v_mov_b32 v101, 0
  v_mov_b32 v102, 0
  v_mov_b32 v103, 0
  v_mov_b32 v104, 0
  v_mov_b32 v105, 0
  v_mov_b32 v106, 0
  v_mov_b32 v107, 0
  v_mov_b32 v108, 0
  v_mov_b32 v109, 0
  v_mov_b32 v110, 0
  v_mov_b32 v111, 0
  v_mov_b32 v112, 0
  v_mov_b32 v113, 0
  v_mov_b32 v114, 0
  v_mov_b32 v115, 0
  s_waitcnt lgkmcnt(0)
  s_mov_b32 s12, s34
  s_and_b32 s13, s35, 0xffff
  s_mov_b32 s14, 268435456
  s_mov_b32 s15, 0x20000
  s_mov_b32 s96, s92
  s_and_b32 s97, s93, 0xffff
  s_mov_b32 s98, 256
  s_mov_b32 s99, 0x20000
  s_barrier
  ds_read_b128 v[116:119], v7 offset:0
  ds_read_b64_tr_b16 v[148:149], v13 offset:0
  ds_read_b64_tr_b16 v[150:151], v13 offset:256
  ds_read_b64_tr_b16 v[152:153], v14 offset:0
  ds_read_b64_tr_b16 v[154:155], v14 offset:256
  ds_read_b64_tr_b16 v[156:157], v13 offset:4096
  ds_read_b64_tr_b16 v[158:159], v13 offset:4352
  ds_read_b64_tr_b16 v[160:161], v14 offset:4096
  ds_read_b64_tr_b16 v[162:163], v14 offset:4352
  ds_read_b64_tr_b16 v[164:165], v13 offset:8192
  ds_read_b64_tr_b16 v[166:167], v13 offset:8448
  ds_read_b64_tr_b16 v[168:169], v14 offset:8192
  ds_read_b64_tr_b16 v[170:171], v14 offset:8448
  ds_read_b128 v[120:123], v7 offset:2048
  ds_read_b128 v[124:127], v7 offset:4096
  ds_read_b128 v[128:131], v7 offset:6144
  s_waitcnt lgkmcnt(0)
  v_mfma_f32_16x16x32_bf16 v[20:23], v[148:151], v[116:119], v[20:23]
  ds_read_b128 v[132:135], v8 offset:0
  v_mfma_f32_16x16x32_bf16 v[24:27], v[152:155], v[116:119], v[24:27]
  ds_read_b64_tr_b16 v[172:173], v13 offset:2048
  v_mfma_f32_16x16x32_bf16 v[28:31], v[156:159], v[116:119], v[28:31]
  ds_read_b64_tr_b16 v[174:175], v13 offset:2304
  v_mfma_f32_16x16x32_bf16 v[32:35], v[160:163], v[116:119], v[32:35]
  ds_read_b64_tr_b16 v[176:177], v14 offset:2048
  v_mfma_f32_16x16x32_bf16 v[36:39], v[116:119], v[164:167], v[36:39]
  ds_read_b64_tr_b16 v[178:179], v14 offset:2304
  v_mfma_f32_16x16x32_bf16 v[40:43], v[116:119], v[168:171], v[40:43]
  ds_read_b64_tr_b16 v[180:181], v13 offset:6144
  v_mfma_f32_16x16x32_bf16 v[44:47], v[148:151], v[120:123], v[44:47]
  ds_read_b64_tr_b16 v[182:183], v13 offset:6400
  v_mfma_f32_16x16x32_bf16 v[48:51], v[152:155], v[120:123], v[48:51]
  ds_read_b64_tr_b16 v[184:185], v14 offset:6144
  v_mfma_f32_16x16x32_bf16 v[52:55], v[156:159], v[120:123], v[52:55]
  ds_read_b64_tr_b16 v[186:187], v14 offset:6400
  v_mfma_f32_16x16x32_bf16 v[56:59], v[160:163], v[120:123], v[56:59]
  ds_read_b64_tr_b16 v[188:189], v13 offset:10240
  v_mfma_f32_16x16x32_bf16 v[60:63], v[120:123], v[164:167], v[60:63]
  ds_read_b64_tr_b16 v[190:191], v13 offset:10496
  v_mfma_f32_16x16x32_bf16 v[64:67], v[120:123], v[168:171], v[64:67]
  ds_read_b64_tr_b16 v[192:193], v14 offset:10240
  v_mfma_f32_16x16x32_bf16 v[68:71], v[148:151], v[124:127], v[68:71]
  ds_read_b64_tr_b16 v[194:195], v14 offset:10496
  v_mfma_f32_16x16x32_bf16 v[72:75], v[152:155], v[124:127], v[72:75]
  ds_read_b128 v[136:139], v8 offset:2048
  v_mfma_f32_16x16x32_bf16 v[76:79], v[156:159], v[124:127], v[76:79]
  ds_read_b128 v[140:143], v8 offset:4096
  v_mfma_f32_16x16x32_bf16 v[80:83], v[160:163], v[124:127], v[80:83]
  ds_read_b128 v[144:147], v8 offset:6144
  v_mfma_f32_16x16x32_bf16 v[84:87], v[124:127], v[164:167], v[84:87]
  v_mfma_f32_16x16x32_bf16 v[88:91], v[124:127], v[168:171], v[88:91]
  v_mfma_f32_16x16x32_bf16 v[92:95], v[148:151], v[128:131], v[92:95]
  v_mfma_f32_16x16x32_bf16 v[96:99], v[152:155], v[128:131], v[96:99]
  v_mfma_f32_16x16x32_bf16 v[100:103], v[156:159], v[128:131], v[100:103]
  v_mfma_f32_16x16x32_bf16 v[104:107], v[160:163], v[128:131], v[104:107]
  v_mfma_f32_16x16x32_bf16 v[108:111], v[128:131], v[164:167], v[108:111]
  v_mfma_f32_16x16x32_bf16 v[112:115], v[128:131], v[168:171], v[112:115]
  s_waitcnt lgkmcnt(0)
  s_barrier
  v_mfma_f32_16x16x32_bf16 v[20:23], v[172:175], v[132:135], v[20:23]
  ds_read_b128 v[116:119], v9 offset:0
  v_mfma_f32_16x16x32_bf16 v[24:27], v[176:179], v[132:135], v[24:27]
  ds_read_b64_tr_b16 v[148:149], v15 offset:0
  v_mfma_f32_16x16x32_bf16 v[28:31], v[180:183], v[132:135], v[28:31]
  ds_read_b64_tr_b16 v[150:151], v15 offset:256
  v_mfma_f32_16x16x32_bf16 v[32:35], v[184:187], v[132:135], v[32:35]
  ds_read_b64_tr_b16 v[152:153], v16 offset:0
  v_mfma_f32_16x16x32_bf16 v[36:39], v[132:135], v[188:191], v[36:39]
  ds_read_b64_tr_b16 v[154:155], v16 offset:256
  v_mfma_f32_16x16x32_bf16 v[40:43], v[132:135], v[192:195], v[40:43]
  ds_read_b64_tr_b16 v[156:157], v15 offset:4096
  v_mfma_f32_16x16x32_bf16 v[44:47], v[172:175], v[136:139], v[44:47]
  ds_read_b64_tr_b16 v[158:159], v15 offset:4352
  v_mfma_f32_16x16x32_bf16 v[48:51], v[176:179], v[136:139], v[48:51]
  ds_read_b64_tr_b16 v[160:161], v16 offset:4096
  v_mfma_f32_16x16x32_bf16 v[52:55], v[180:183], v[136:139], v[52:55]
  ds_read_b64_tr_b16 v[162:163], v16 offset:4352
  v_mfma_f32_16x16x32_bf16 v[56:59], v[184:187], v[136:139], v[56:59]
  ds_read_b64_tr_b16 v[164:165], v15 offset:8192
  v_mfma_f32_16x16x32_bf16 v[60:63], v[136:139], v[188:191], v[60:63]
  ds_read_b64_tr_b16 v[166:167], v15 offset:8448
  v_mfma_f32_16x16x32_bf16 v[64:67], v[136:139], v[192:195], v[64:67]
  ds_read_b64_tr_b16 v[168:169], v16 offset:8192
  v_mfma_f32_16x16x32_bf16 v[68:71], v[172:175], v[140:143], v[68:71]
  ds_read_b64_tr_b16 v[170:171], v16 offset:8448
  v_mfma_f32_16x16x32_bf16 v[72:75], v[176:179], v[140:143], v[72:75]
  ds_read_b128 v[120:123], v9 offset:2048
  v_mfma_f32_16x16x32_bf16 v[76:79], v[180:183], v[140:143], v[76:79]
  ds_read_b128 v[124:127], v9 offset:4096
  v_mfma_f32_16x16x32_bf16 v[80:83], v[184:187], v[140:143], v[80:83]
  ds_read_b128 v[128:131], v9 offset:6144
  v_mfma_f32_16x16x32_bf16 v[84:87], v[140:143], v[188:191], v[84:87]
  v_mfma_f32_16x16x32_bf16 v[88:91], v[140:143], v[192:195], v[88:91]
  v_mfma_f32_16x16x32_bf16 v[92:95], v[172:175], v[144:147], v[92:95]
  v_mfma_f32_16x16x32_bf16 v[96:99], v[176:179], v[144:147], v[96:99]
  v_mfma_f32_16x16x32_bf16 v[100:103], v[180:183], v[144:147], v[100:103]
  v_mfma_f32_16x16x32_bf16 v[104:107], v[184:187], v[144:147], v[104:107]
  v_mfma_f32_16x16x32_bf16 v[108:111], v[144:147], v[188:191], v[108:111]
  v_mfma_f32_16x16x32_bf16 v[112:115], v[144:147], v[192:195], v[112:115]
  s_waitcnt lgkmcnt(0)
  v_mfma_f32_16x16x32_bf16 v[20:23], v[148:151], v[116:119], v[20:23]
  ds_read_b128 v[132:135], v10 offset:0
  v_mfma_f32_16x16x32_bf16 v[24:27], v[152:155], v[116:119], v[24:27]
  ds_read_b64_tr_b16 v[172:173], v15 offset:2048
  v_mfma_f32_16x16x32_bf16 v[28:31], v[156:159], v[116:119], v[28:31]
  ds_read_b64_tr_b16 v[174:175], v15 offset:2304
  v_mfma_f32_16x16x32_bf16 v[32:35], v[160:163], v[116:119], v[32:35]
  ds_read_b64_tr_b16 v[176:177], v16 offset:2048
  v_mfma_f32_16x16x32_bf16 v[36:39], v[116:119], v[164:167], v[36:39]
  ds_read_b64_tr_b16 v[178:179], v16 offset:2304
  v_mfma_f32_16x16x32_bf16 v[40:43], v[116:119], v[168:171], v[40:43]
  ds_read_b64_tr_b16 v[180:181], v15 offset:6144
  v_mfma_f32_16x16x32_bf16 v[44:47], v[148:151], v[120:123], v[44:47]
  ds_read_b64_tr_b16 v[182:183], v15 offset:6400
  v_mfma_f32_16x16x32_bf16 v[48:51], v[152:155], v[120:123], v[48:51]
  ds_read_b64_tr_b16 v[184:185], v16 offset:6144
  v_mfma_f32_16x16x32_bf16 v[52:55], v[156:159], v[120:123], v[52:55]
  ds_read_b64_tr_b16 v[186:187], v16 offset:6400
  v_mfma_f32_16x16x32_bf16 v[56:59], v[160:163], v[120:123], v[56:59]
  ds_read_b64_tr_b16 v[188:189], v15 offset:10240
  v_mfma_f32_16x16x32_bf16 v[60:63], v[120:123], v[164:167], v[60:63]
  ds_read_b64_tr_b16 v[190:191], v15 offset:10496
  v_mfma_f32_16x16x32_bf16 v[64:67], v[120:123], v[168:171], v[64:67]
  ds_read_b64_tr_b16 v[192:193], v16 offset:10240
  v_mfma_f32_16x16x32_bf16 v[68:71], v[148:151], v[124:127], v[68:71]
  ds_read_b64_tr_b16 v[194:195], v16 offset:10496
  v_mfma_f32_16x16x32_bf16 v[72:75], v[152:155], v[124:127], v[72:75]
  ds_read_b128 v[136:139], v10 offset:2048
  v_mfma_f32_16x16x32_bf16 v[76:79], v[156:159], v[124:127], v[76:79]
  ds_read_b128 v[140:143], v10 offset:4096
  v_mfma_f32_16x16x32_bf16 v[80:83], v[160:163], v[124:127], v[80:83]
  ds_read_b128 v[144:147], v10 offset:6144
  v_mfma_f32_16x16x32_bf16 v[84:87], v[124:127], v[164:167], v[84:87]
  v_mfma_f32_16x16x32_bf16 v[88:91], v[124:127], v[168:171], v[88:91]
  v_mfma_f32_16x16x32_bf16 v[92:95], v[148:151], v[128:131], v[92:95]
  v_mfma_f32_16x16x32_bf16 v[96:99], v[152:155], v[128:131], v[96:99]
  v_mfma_f32_16x16x32_bf16 v[100:103], v[156:159], v[128:131], v[100:103]
  v_mfma_f32_16x16x32_bf16 v[104:107], v[160:163], v[128:131], v[104:107]
  v_mfma_f32_16x16x32_bf16 v[108:111], v[128:131], v[164:167], v[108:111]
  v_mfma_f32_16x16x32_bf16 v[112:115], v[128:131], v[168:171], v[112:115]
  s_waitcnt lgkmcnt(0)
  s_barrier
  v_mfma_f32_16x16x32_bf16 v[20:23], v[172:175], v[132:135], v[20:23]
  ds_read_b128 v[116:119], v11 offset:0
  v_mfma_f32_16x16x32_bf16 v[24:27], v[176:179], v[132:135], v[24:27]
  ds_read_b64_tr_b16 v[148:149], v17 offset:0
  v_mfma_f32_16x16x32_bf16 v[28:31], v[180:183], v[132:135], v[28:31]
  ds_read_b64_tr_b16 v[150:151], v17 offset:256
  v_mfma_f32_16x16x32_bf16 v[32:35], v[184:187], v[132:135], v[32:35]
  ds_read_b64_tr_b16 v[152:153], v18 offset:0
  v_mfma_f32_16x16x32_bf16 v[36:39], v[132:135], v[188:191], v[36:39]
  ds_read_b64_tr_b16 v[154:155], v18 offset:256
  v_mfma_f32_16x16x32_bf16 v[40:43], v[132:135], v[192:195], v[40:43]
  ds_read_b64_tr_b16 v[156:157], v17 offset:4096
  v_mfma_f32_16x16x32_bf16 v[44:47], v[172:175], v[136:139], v[44:47]
  ds_read_b64_tr_b16 v[158:159], v17 offset:4352
  v_mfma_f32_16x16x32_bf16 v[48:51], v[176:179], v[136:139], v[48:51]
  ds_read_b64_tr_b16 v[160:161], v18 offset:4096
  v_mfma_f32_16x16x32_bf16 v[52:55], v[180:183], v[136:139], v[52:55]
  ds_read_b64_tr_b16 v[162:163], v18 offset:4352
  v_mfma_f32_16x16x32_bf16 v[56:59], v[184:187], v[136:139], v[56:59]
  ds_read_b64_tr_b16 v[164:165], v17 offset:8192
  v_mfma_f32_16x16x32_bf16 v[60:63], v[136:139], v[188:191], v[60:63]
  ds_read_b64_tr_b16 v[166:167], v17 offset:8448
  v_mfma_f32_16x16x32_bf16 v[64:67], v[136:139], v[192:195], v[64:67]
  ds_read_b64_tr_b16 v[168:169], v18 offset:8192
  v_mfma_f32_16x16x32_bf16 v[68:71], v[172:175], v[140:143], v[68:71]
  ds_read_b64_tr_b16 v[170:171], v18 offset:8448
  v_mfma_f32_16x16x32_bf16 v[72:75], v[176:179], v[140:143], v[72:75]
  ds_read_b128 v[120:123], v11 offset:2048
  v_mfma_f32_16x16x32_bf16 v[76:79], v[180:183], v[140:143], v[76:79]
  ds_read_b128 v[124:127], v11 offset:4096
  v_mfma_f32_16x16x32_bf16 v[80:83], v[184:187], v[140:143], v[80:83]
  ds_read_b128 v[128:131], v11 offset:6144
  v_mfma_f32_16x16x32_bf16 v[84:87], v[140:143], v[188:191], v[84:87]
  v_mfma_f32_16x16x32_bf16 v[88:91], v[140:143], v[192:195], v[88:91]
  v_mfma_f32_16x16x32_bf16 v[92:95], v[172:175], v[144:147], v[92:95]
  v_mfma_f32_16x16x32_bf16 v[96:99], v[176:179], v[144:147], v[96:99]
  v_mfma_f32_16x16x32_bf16 v[100:103], v[180:183], v[144:147], v[100:103]
  v_mfma_f32_16x16x32_bf16 v[104:107], v[184:187], v[144:147], v[104:107]
  v_mfma_f32_16x16x32_bf16 v[108:111], v[144:147], v[188:191], v[108:111]
  v_mfma_f32_16x16x32_bf16 v[112:115], v[144:147], v[192:195], v[112:115]
  s_waitcnt lgkmcnt(0)
  v_mfma_f32_16x16x32_bf16 v[20:23], v[148:151], v[116:119], v[20:23]
  ds_read_b128 v[132:135], v12 offset:0
  v_mfma_f32_16x16x32_bf16 v[24:27], v[152:155], v[116:119], v[24:27]
  ds_read_b64_tr_b16 v[172:173], v17 offset:2048
  v_mfma_f32_16x16x32_bf16 v[28:31], v[156:159], v[116:119], v[28:31]
  ds_read_b64_tr_b16 v[174:175], v17 offset:2304
  v_mfma_f32_16x16x32_bf16 v[32:35], v[160:163], v[116:119], v[32:35]
  ds_read_b64_tr_b16 v[176:177], v18 offset:2048
  v_mfma_f32_16x16x32_bf16 v[36:39], v[116:119], v[164:167], v[36:39]
  ds_read_b64_tr_b16 v[178:179], v18 offset:2304
  v_mfma_f32_16x16x32_bf16 v[40:43], v[116:119], v[168:171], v[40:43]
  ds_read_b64_tr_b16 v[180:181], v17 offset:6144
  v_mfma_f32_16x16x32_bf16 v[44:47], v[148:151], v[120:123], v[44:47]
  ds_read_b64_tr_b16 v[182:183], v17 offset:6400
  v_mfma_f32_16x16x32_bf16 v[48:51], v[152:155], v[120:123], v[48:51]
  ds_read_b64_tr_b16 v[184:185], v18 offset:6144
  v_mfma_f32_16x16x32_bf16 v[52:55], v[156:159], v[120:123], v[52:55]
  ds_read_b64_tr_b16 v[186:187], v18 offset:6400
  v_mfma_f32_16x16x32_bf16 v[56:59], v[160:163], v[120:123], v[56:59]
  ds_read_b64_tr_b16 v[188:189], v17 offset:10240
  v_mfma_f32_16x16x32_bf16 v[60:63], v[120:123], v[164:167], v[60:63]
  ds_read_b64_tr_b16 v[190:191], v17 offset:10496
  v_mfma_f32_16x16x32_bf16 v[64:67], v[120:123], v[168:171], v[64:67]
  ds_read_b64_tr_b16 v[192:193], v18 offset:10240
  v_mfma_f32_16x16x32_bf16 v[68:71], v[148:151], v[124:127], v[68:71]
  ds_read_b64_tr_b16 v[194:195], v18 offset:10496
  v_mfma_f32_16x16x32_bf16 v[72:75], v[152:155], v[124:127], v[72:75]
  ds_read_b128 v[136:139], v12 offset:2048
  v_mfma_f32_16x16x32_bf16 v[76:79], v[156:159], v[124:127], v[76:79]
  ds_read_b128 v[140:143], v12 offset:4096
  v_mfma_f32_16x16x32_bf16 v[80:83], v[160:163], v[124:127], v[80:83]
  ds_read_b128 v[144:147], v12 offset:6144
  v_mfma_f32_16x16x32_bf16 v[84:87], v[124:127], v[164:167], v[84:87]
  v_mfma_f32_16x16x32_bf16 v[88:91], v[124:127], v[168:171], v[88:91]
  v_mfma_f32_16x16x32_bf16 v[92:95], v[148:151], v[128:131], v[92:95]
  v_mfma_f32_16x16x32_bf16 v[96:99], v[152:155], v[128:131], v[96:99]
  v_mfma_f32_16x16x32_bf16 v[100:103], v[156:159], v[128:131], v[100:103]
  v_mfma_f32_16x16x32_bf16 v[104:107], v[160:163], v[128:131], v[104:107]
  v_mfma_f32_16x16x32_bf16 v[108:111], v[128:131], v[164:167], v[108:111]
  v_mfma_f32_16x16x32_bf16 v[112:115], v[128:131], v[168:171], v[112:115]
  s_waitcnt lgkmcnt(0)
  s_barrier
  v_mfma_f32_16x16x32_bf16 v[20:23], v[172:175], v[132:135], v[20:23]
  ds_read_b128 v[116:119], v7 offset:0
  v_mfma_f32_16x16x32_bf16 v[24:27], v[176:179], v[132:135], v[24:27]
  ds_read_b64_tr_b16 v[148:149], v13 offset:0
  v_mfma_f32_16x16x32_bf16 v[28:31], v[180:183], v[132:135], v[28:31]
  ds_read_b64_tr_b16 v[150:151], v13 offset:256
  v_mfma_f32_16x16x32_bf16 v[32:35], v[184:187], v[132:135], v[32:35]
  ds_read_b64_tr_b16 v[152:153], v14 offset:0
  v_mfma_f32_16x16x32_bf16 v[36:39], v[132:135], v[188:191], v[36:39]
  ds_read_b64_tr_b16 v[154:155], v14 offset:256
  v_mfma_f32_16x16x32_bf16 v[40:43], v[132:135], v[192:195], v[40:43]
  ds_read_b64_tr_b16 v[156:157], v13 offset:4096
  v_mfma_f32_16x16x32_bf16 v[44:47], v[172:175], v[136:139], v[44:47]
  ds_read_b64_tr_b16 v[158:159], v13 offset:4352
  v_mfma_f32_16x16x32_bf16 v[48:51], v[176:179], v[136:139], v[48:51]
  ds_read_b64_tr_b16 v[160:161], v14 offset:4096
  v_mfma_f32_16x16x32_bf16 v[52:55], v[180:183], v[136:139], v[52:55]
  ds_read_b64_tr_b16 v[162:163], v14 offset:4352
  v_mfma_f32_16x16x32_bf16 v[56:59], v[184:187], v[136:139], v[56:59]
  ds_read_b64_tr_b16 v[164:165], v13 offset:8192
  v_mfma_f32_16x16x32_bf16 v[60:63], v[136:139], v[188:191], v[60:63]
  ds_read_b64_tr_b16 v[166:167], v13 offset:8448
  v_mfma_f32_16x16x32_bf16 v[64:67], v[136:139], v[192:195], v[64:67]
  ds_read_b64_tr_b16 v[168:169], v14 offset:8192
  v_mfma_f32_16x16x32_bf16 v[68:71], v[172:175], v[140:143], v[68:71]
  ds_read_b64_tr_b16 v[170:171], v14 offset:8448
  v_mfma_f32_16x16x32_bf16 v[72:75], v[176:179], v[140:143], v[72:75]
  ds_read_b128 v[120:123], v7 offset:2048
  v_mfma_f32_16x16x32_bf16 v[76:79], v[180:183], v[140:143], v[76:79]
  ds_read_b128 v[124:127], v7 offset:4096
  v_mfma_f32_16x16x32_bf16 v[80:83], v[184:187], v[140:143], v[80:83]
  ds_read_b128 v[128:131], v7 offset:6144
  v_mfma_f32_16x16x32_bf16 v[84:87], v[140:143], v[188:191], v[84:87]
  v_mfma_f32_16x16x32_bf16 v[88:91], v[140:143], v[192:195], v[88:91]
  v_mfma_f32_16x16x32_bf16 v[92:95], v[172:175], v[144:147], v[92:95]
  v_mfma_f32_16x16x32_bf16 v[96:99], v[176:179], v[144:147], v[96:99]
  v_mfma_f32_16x16x32_bf16 v[100:103], v[180:183], v[144:147], v[100:103]
  v_mfma_f32_16x16x32_bf16 v[104:107], v[184:187], v[144:147], v[104:107]
  v_mfma_f32_16x16x32_bf16 v[108:111], v[144:147], v[188:191], v[108:111]
  v_mfma_f32_16x16x32_bf16 v[112:115], v[144:147], v[192:195], v[112:115]
  s_waitcnt lgkmcnt(0)
  v_mfma_f32_16x16x32_bf16 v[20:23], v[148:151], v[116:119], v[20:23]
  ds_read_b128 v[132:135], v8 offset:0
  v_mfma_f32_16x16x32_bf16 v[24:27], v[152:155], v[116:119], v[24:27]
  ds_read_b64_tr_b16 v[172:173], v13 offset:2048
  v_mfma_f32_16x16x32_bf16 v[28:31], v[156:159], v[116:119], v[28:31]
  ds_read_b64_tr_b16 v[174:175], v13 offset:2304
  v_mfma_f32_16x16x32_bf16 v[32:35], v[160:163], v[116:119], v[32:35]
  ds_read_b64_tr_b16 v[176:177], v14 offset:2048
  v_mfma_f32_16x16x32_bf16 v[36:39], v[116:119], v[164:167], v[36:39]
  ds_read_b64_tr_b16 v[178:179], v14 offset:2304
  v_mfma_f32_16x16x32_bf16 v[40:43], v[116:119], v[168:171], v[40:43]
  ds_read_b64_tr_b16 v[180:181], v13 offset:6144
  v_mfma_f32_16x16x32_bf16 v[44:47], v[148:151], v[120:123], v[44:47]
  ds_read_b64_tr_b16 v[182:183], v13 offset:6400
  v_mfma_f32_16x16x32_bf16 v[48:51], v[152:155], v[120:123], v[48:51]
  ds_read_b64_tr_b16 v[184:185], v14 offset:6144
  v_mfma_f32_16x16x32_bf16 v[52:55], v[156:159], v[120:123], v[52:55]
  ds_read_b64_tr_b16 v[186:187], v14 offset:6400
  v_mfma_f32_16x16x32_bf16 v[56:59], v[160:163], v[120:123], v[56:59]
  ds_read_b64_tr_b16 v[188:189], v13 offset:10240
  v_mfma_f32_16x16x32_bf16 v[60:63], v[120:123], v[164:167], v[60:63]
  ds_read_b64_tr_b16 v[190:191], v13 offset:10496
  v_mfma_f32_16x16x32_bf16 v[64:67], v[120:123], v[168:171], v[64:67]
  ds_read_b64_tr_b16 v[192:193], v14 offset:10240
  v_mfma_f32_16x16x32_bf16 v[68:71], v[148:151], v[124:127], v[68:71]
  ds_read_b64_tr_b16 v[194:195], v14 offset:10496
  v_mfma_f32_16x16x32_bf16 v[72:75], v[152:155], v[124:127], v[72:75]
  ds_read_b128 v[136:139], v8 offset:2048
  v_mfma_f32_16x16x32_bf16 v[76:79], v[156:159], v[124:127], v[76:79]
  ds_read_b128 v[140:143], v8 offset:4096
  v_mfma_f32_16x16x32_bf16 v[80:83], v[160:163], v[124:127], v[80:83]
  ds_read_b128 v[144:147], v8 offset:6144
  v_mfma_f32_16x16x32_bf16 v[84:87], v[124:127], v[164:167], v[84:87]
  v_mfma_f32_16x16x32_bf16 v[88:91], v[124:127], v[168:171], v[88:91]
  v_mfma_f32_16x16x32_bf16 v[92:95], v[148:151], v[128:131], v[92:95]
  v_mfma_f32_16x16x32_bf16 v[96:99], v[152:155], v[128:131], v[96:99]
  v_mfma_f32_16x16x32_bf16 v[100:103], v[156:159], v[128:131], v[100:103]
  v_mfma_f32_16x16x32_bf16 v[104:107], v[160:163], v[128:131], v[104:107]
  v_mfma_f32_16x16x32_bf16 v[108:111], v[128:131], v[164:167], v[108:111]
  v_mfma_f32_16x16x32_bf16 v[112:115], v[128:131], v[168:171], v[112:115]
  s_waitcnt lgkmcnt(0)
  s_barrier
  v_mfma_f32_16x16x32_bf16 v[20:23], v[172:175], v[132:135], v[20:23]
  ds_read_b128 v[116:119], v9 offset:0
  v_mfma_f32_16x16x32_bf16 v[24:27], v[176:179], v[132:135], v[24:27]
  ds_read_b64_tr_b16 v[148:149], v15 offset:0
  v_mfma_f32_16x16x32_bf16 v[28:31], v[180:183], v[132:135], v[28:31]
  ds_read_b64_tr_b16 v[150:151], v15 offset:256
  v_mfma_f32_16x16x32_bf16 v[32:35], v[184:187], v[132:135], v[32:35]
  ds_read_b64_tr_b16 v[152:153], v16 offset:0
  v_mfma_f32_16x16x32_bf16 v[36:39], v[132:135], v[188:191], v[36:39]
  ds_read_b64_tr_b16 v[154:155], v16 offset:256
  v_mfma_f32_16x16x32_bf16 v[40:43], v[132:135], v[192:195], v[40:43]
  ds_read_b64_tr_b16 v[156:157], v15 offset:4096
  v_mfma_f32_16x16x32_bf16 v[44:47], v[172:175], v[136:139], v[44:47]
  ds_read_b64_tr_b16 v[158:159], v15 offset:4352
  v_mfma_f32_16x16x32_bf16 v[48:51], v[176:179], v[136:139], v[48:51]
  ds_read_b64_tr_b16 v[160:161], v16 offset:4096
  v_mfma_f32_16x16x32_bf16 v[52:55], v[180:183], v[136:139], v[52:55]
  ds_read_b64_tr_b16 v[162:163], v16 offset:4352
  v_mfma_f32_16x16x32_bf16 v[56:59], v[184:187], v[136:139], v[56:59]
  ds_read_b64_tr_b16 v[164:165], v15 offset:8192
  v_mfma_f32_16x16x32_bf16 v[60:63], v[136:139], v[188:191], v[60:63]
  ds_read_b64_tr_b16 v[166:167], v15 offset:8448
  v_mfma_f32_16x16x32_bf16 v[64:67], v[136:139], v[192:195], v[64:67]
  ds_read_b64_tr_b16 v[168:169], v16 offset:8192
  v_mfma_f32_16x16x32_bf16 v[68:71], v[172:175], v[140:143], v[68:71]
  ds_read_b64_tr_b16 v[170:171], v16 offset:8448
  v_mfma_f32_16x16x32_bf16 v[72:75], v[176:179], v[140:143], v[72:75]
  ds_read_b128 v[120:123], v9 offset:2048
  v_mfma_f32_16x16x32_bf16 v[76:79], v[180:183], v[140:143], v[76:79]
  ds_read_b128 v[124:127], v9 offset:4096
  v_mfma_f32_16x16x32_bf16 v[80:83], v[184:187], v[140:143], v[80:83]
  ds_read_b128 v[128:131], v9 offset:6144
  v_mfma_f32_16x16x32_bf16 v[84:87], v[140:143], v[188:191], v[84:87]
  v_mfma_f32_16x16x32_bf16 v[88:91], v[140:143], v[192:195], v[88:91]
  v_mfma_f32_16x16x32_bf16 v[92:95], v[172:175], v[144:147], v[92:95]
  v_mfma_f32_16x16x32_bf16 v[96:99], v[176:179], v[144:147], v[96:99]
  v_mfma_f32_16x16x32_bf16 v[100:103], v[180:183], v[144:147], v[100:103]
  v_mfma_f32_16x16x32_bf16 v[104:107], v[184:187], v[144:147], v[104:107]
  v_mfma_f32_16x16x32_bf16 v[108:111], v[144:147], v[188:191], v[108:111]
  v_mfma_f32_16x16x32_bf16 v[112:115], v[144:147], v[192:195], v[112:115]
  s_waitcnt lgkmcnt(0)
  v_mfma_f32_16x16x32_bf16 v[20:23], v[148:151], v[116:119], v[20:23]
  ds_read_b128 v[132:135], v10 offset:0
  v_mfma_f32_16x16x32_bf16 v[24:27], v[152:155], v[116:119], v[24:27]
  ds_read_b64_tr_b16 v[172:173], v15 offset:2048
  v_mfma_f32_16x16x32_bf16 v[28:31], v[156:159], v[116:119], v[28:31]
  ds_read_b64_tr_b16 v[174:175], v15 offset:2304
  v_mfma_f32_16x16x32_bf16 v[32:35], v[160:163], v[116:119], v[32:35]
  ds_read_b64_tr_b16 v[176:177], v16 offset:2048
  v_mfma_f32_16x16x32_bf16 v[36:39], v[116:119], v[164:167], v[36:39]
  ds_read_b64_tr_b16 v[178:179], v16 offset:2304
  v_mfma_f32_16x16x32_bf16 v[40:43], v[116:119], v[168:171], v[40:43]
  ds_read_b64_tr_b16 v[180:181], v15 offset:6144
  v_mfma_f32_16x16x32_bf16 v[44:47], v[148:151], v[120:123], v[44:47]
  ds_read_b64_tr_b16 v[182:183], v15 offset:6400
  v_mfma_f32_16x16x32_bf16 v[48:51], v[152:155], v[120:123], v[48:51]
  ds_read_b64_tr_b16 v[184:185], v16 offset:6144
  v_mfma_f32_16x16x32_bf16 v[52:55], v[156:159], v[120:123], v[52:55]
  ds_read_b64_tr_b16 v[186:187], v16 offset:6400
  v_mfma_f32_16x16x32_bf16 v[56:59], v[160:163], v[120:123], v[56:59]
  ds_read_b64_tr_b16 v[188:189], v15 offset:10240
  v_mfma_f32_16x16x32_bf16 v[60:63], v[120:123], v[164:167], v[60:63]
  ds_read_b64_tr_b16 v[190:191], v15 offset:10496
  v_mfma_f32_16x16x32_bf16 v[64:67], v[120:123], v[168:171], v[64:67]
  ds_read_b64_tr_b16 v[192:193], v16 offset:10240
  v_mfma_f32_16x16x32_bf16 v[68:71], v[148:151], v[124:127], v[68:71]
  ds_read_b64_tr_b16 v[194:195], v16 offset:10496
  v_mfma_f32_16x16x32_bf16 v[72:75], v[152:155], v[124:127], v[72:75]
  ds_read_b128 v[136:139], v10 offset:2048
  v_mfma_f32_16x16x32_bf16 v[76:79], v[156:159], v[124:127], v[76:79]
  ds_read_b128 v[140:143], v10 offset:4096
  v_mfma_f32_16x16x32_bf16 v[80:83], v[160:163], v[124:127], v[80:83]
  ds_read_b128 v[144:147], v10 offset:6144
  v_mfma_f32_16x16x32_bf16 v[84:87], v[124:127], v[164:167], v[84:87]
  v_mfma_f32_16x16x32_bf16 v[88:91], v[124:127], v[168:171], v[88:91]
  v_mfma_f32_16x16x32_bf16 v[92:95], v[148:151], v[128:131], v[92:95]
  v_mfma_f32_16x16x32_bf16 v[96:99], v[152:155], v[128:131], v[96:99]
  v_mfma_f32_16x16x32_bf16 v[100:103], v[156:159], v[128:131], v[100:103]
  v_mfma_f32_16x16x32_bf16 v[104:107], v[160:163], v[128:131], v[104:107]
  v_mfma_f32_16x16x32_bf16 v[108:111], v[128:131], v[164:167], v[108:111]
  v_mfma_f32_16x16x32_bf16 v[112:115], v[128:131], v[168:171], v[112:115]
  s_waitcnt lgkmcnt(0)
  s_barrier
  v_mfma_f32_16x16x32_bf16 v[20:23], v[172:175], v[132:135], v[20:23]
  ds_read_b128 v[116:119], v11 offset:0
  v_mfma_f32_16x16x32_bf16 v[24:27], v[176:179], v[132:135], v[24:27]
  ds_read_b64_tr_b16 v[148:149], v17 offset:0
  v_mfma_f32_16x16x32_bf16 v[28:31], v[180:183], v[132:135], v[28:31]
  ds_read_b64_tr_b16 v[150:151], v17 offset:256
  v_mfma_f32_16x16x32_bf16 v[32:35], v[184:187], v[132:135], v[32:35]
  ds_read_b64_tr_b16 v[152:153], v18 offset:0
  v_mfma_f32_16x16x32_bf16 v[36:39], v[132:135], v[188:191], v[36:39]
  ds_read_b64_tr_b16 v[154:155], v18 offset:256
  v_mfma_f32_16x16x32_bf16 v[40:43], v[132:135], v[192:195], v[40:43]
  ds_read_b64_tr_b16 v[156:157], v17 offset:4096
  v_mfma_f32_16x16x32_bf16 v[44:47], v[172:175], v[136:139], v[44:47]
  ds_read_b64_tr_b16 v[158:159], v17 offset:4352
  v_mfma_f32_16x16x32_bf16 v[48:51], v[176:179], v[136:139], v[48:51]
  ds_read_b64_tr_b16 v[160:161], v18 offset:4096
  v_mfma_f32_16x16x32_bf16 v[52:55], v[180:183], v[136:139], v[52:55]
  ds_read_b64_tr_b16 v[162:163], v18 offset:4352
  v_mfma_f32_16x16x32_bf16 v[56:59], v[184:187], v[136:139], v[56:59]
  ds_read_b64_tr_b16 v[164:165], v17 offset:8192
  v_mfma_f32_16x16x32_bf16 v[60:63], v[136:139], v[188:191], v[60:63]
  ds_read_b64_tr_b16 v[166:167], v17 offset:8448
  v_mfma_f32_16x16x32_bf16 v[64:67], v[136:139], v[192:195], v[64:67]
  ds_read_b64_tr_b16 v[168:169], v18 offset:8192
  v_mfma_f32_16x16x32_bf16 v[68:71], v[172:175], v[140:143], v[68:71]
  ds_read_b64_tr_b16 v[170:171], v18 offset:8448
  v_mfma_f32_16x16x32_bf16 v[72:75], v[176:179], v[140:143], v[72:75]
  ds_read_b128 v[120:123], v11 offset:2048
  v_mfma_f32_16x16x32_bf16 v[76:79], v[180:183], v[140:143], v[76:79]
  ds_read_b128 v[124:127], v11 offset:4096
  v_mfma_f32_16x16x32_bf16 v[80:83], v[184:187], v[140:143], v[80:83]
  ds_read_b128 v[128:131], v11 offset:6144
  v_mfma_f32_16x16x32_bf16 v[84:87], v[140:143], v[188:191], v[84:87]
  v_mfma_f32_16x16x32_bf16 v[88:91], v[140:143], v[192:195], v[88:91]
  v_mfma_f32_16x16x32_bf16 v[92:95], v[172:175], v[144:147], v[92:95]
  v_mfma_f32_16x16x32_bf16 v[96:99], v[176:179], v[144:147], v[96:99]
  v_mfma_f32_16x16x32_bf16 v[100:103], v[180:183], v[144:147], v[100:103]
  v_mfma_f32_16x16x32_bf16 v[104:107], v[184:187], v[144:147], v[104:107]
  v_mfma_f32_16x16x32_bf16 v[108:111], v[144:147], v[188:191], v[108:111]
  v_mfma_f32_16x16x32_bf16 v[112:115], v[144:147], v[192:195], v[112:115]
  s_waitcnt lgkmcnt(0)
  v_mfma_f32_16x16x32_bf16 v[20:23], v[148:151], v[116:119], v[20:23]
  ds_read_b128 v[132:135], v12 offset:0
  v_mfma_f32_16x16x32_bf16 v[24:27], v[152:155], v[116:119], v[24:27]
  ds_read_b64_tr_b16 v[172:173], v17 offset:2048
  v_mfma_f32_16x16x32_bf16 v[28:31], v[156:159], v[116:119], v[28:31]
  ds_read_b64_tr_b16 v[174:175], v17 offset:2304
  v_mfma_f32_16x16x32_bf16 v[32:35], v[160:163], v[116:119], v[32:35]
  ds_read_b64_tr_b16 v[176:177], v18 offset:2048
  v_mfma_f32_16x16x32_bf16 v[36:39], v[116:119], v[164:167], v[36:39]
  ds_read_b64_tr_b16 v[178:179], v18 offset:2304
  v_mfma_f32_16x16x32_bf16 v[40:43], v[116:119], v[168:171], v[40:43]
  ds_read_b64_tr_b16 v[180:181], v17 offset:6144
  v_mfma_f32_16x16x32_bf16 v[44:47], v[148:151], v[120:123], v[44:47]
  ds_read_b64_tr_b16 v[182:183], v17 offset:6400
  v_mfma_f32_16x16x32_bf16 v[48:51], v[152:155], v[120:123], v[48:51]
  ds_read_b64_tr_b16 v[184:185], v18 offset:6144
  v_mfma_f32_16x16x32_bf16 v[52:55], v[156:159], v[120:123], v[52:55]
  ds_read_b64_tr_b16 v[186:187], v18 offset:6400
  v_mfma_f32_16x16x32_bf16 v[56:59], v[160:163], v[120:123], v[56:59]
  ds_read_b64_tr_b16 v[188:189], v17 offset:10240
  v_mfma_f32_16x16x32_bf16 v[60:63], v[120:123], v[164:167], v[60:63]
  ds_read_b64_tr_b16 v[190:191], v17 offset:10496
  v_mfma_f32_16x16x32_bf16 v[64:67], v[120:123], v[168:171], v[64:67]
  ds_read_b64_tr_b16 v[192:193], v18 offset:10240
  v_mfma_f32_16x16x32_bf16 v[68:71], v[148:151], v[124:127], v[68:71]
  ds_read_b64_tr_b16 v[194:195], v18 offset:10496
  v_mfma_f32_16x16x32_bf16 v[72:75], v[152:155], v[124:127], v[72:75]
  ds_read_b128 v[136:139], v12 offset:2048
  v_mfma_f32_16x16x32_bf16 v[76:79], v[156:159], v[124:127], v[76:79]
  ds_read_b128 v[140:143], v12 offset:4096
  v_mfma_f32_16x16x32_bf16 v[80:83], v[160:163], v[124:127], v[80:83]
  ds_read_b128 v[144:147], v12 offset:6144
  v_mfma_f32_16x16x32_bf16 v[84:87], v[124:127], v[164:167], v[84:87]
  v_mfma_f32_16x16x32_bf16 v[88:91], v[124:127], v[168:171], v[88:91]
  v_mfma_f32_16x16x32_bf16 v[92:95], v[148:151], v[128:131], v[92:95]
  v_mfma_f32_16x16x32_bf16 v[96:99], v[152:155], v[128:131], v[96:99]
  v_mfma_f32_16x16x32_bf16 v[100:103], v[156:159], v[128:131], v[100:103]
  v_mfma_f32_16x16x32_bf16 v[104:107], v[160:163], v[128:131], v[104:107]
  v_mfma_f32_16x16x32_bf16 v[108:111], v[128:131], v[164:167], v[108:111]
  v_mfma_f32_16x16x32_bf16 v[112:115], v[128:131], v[168:171], v[112:115]
  s_waitcnt lgkmcnt(0)
  s_barrier
  v_mfma_f32_16x16x32_bf16 v[20:23], v[172:175], v[132:135], v[20:23]
  ds_read_b128 v[116:119], v7 offset:0
  v_mfma_f32_16x16x32_bf16 v[24:27], v[176:179], v[132:135], v[24:27]
  ds_read_b64_tr_b16 v[148:149], v13 offset:0
  v_mfma_f32_16x16x32_bf16 v[28:31], v[180:183], v[132:135], v[28:31]
  ds_read_b64_tr_b16 v[150:151], v13 offset:256
  v_mfma_f32_16x16x32_bf16 v[32:35], v[184:187], v[132:135], v[32:35]
  ds_read_b64_tr_b16 v[152:153], v14 offset:0
  v_mfma_f32_16x16x32_bf16 v[36:39], v[132:135], v[188:191], v[36:39]
  ds_read_b64_tr_b16 v[154:155], v14 offset:256
  v_mfma_f32_16x16x32_bf16 v[40:43], v[132:135], v[192:195], v[40:43]
  ds_read_b64_tr_b16 v[156:157], v13 offset:4096
  v_mfma_f32_16x16x32_bf16 v[44:47], v[172:175], v[136:139], v[44:47]
  ds_read_b64_tr_b16 v[158:159], v13 offset:4352
  v_mfma_f32_16x16x32_bf16 v[48:51], v[176:179], v[136:139], v[48:51]
  ds_read_b64_tr_b16 v[160:161], v14 offset:4096
  v_mfma_f32_16x16x32_bf16 v[52:55], v[180:183], v[136:139], v[52:55]
  ds_read_b64_tr_b16 v[162:163], v14 offset:4352
  v_mfma_f32_16x16x32_bf16 v[56:59], v[184:187], v[136:139], v[56:59]
  ds_read_b64_tr_b16 v[164:165], v13 offset:8192
  v_mfma_f32_16x16x32_bf16 v[60:63], v[136:139], v[188:191], v[60:63]
  ds_read_b64_tr_b16 v[166:167], v13 offset:8448
  v_mfma_f32_16x16x32_bf16 v[64:67], v[136:139], v[192:195], v[64:67]
  ds_read_b64_tr_b16 v[168:169], v14 offset:8192
  v_mfma_f32_16x16x32_bf16 v[68:71], v[172:175], v[140:143], v[68:71]
  ds_read_b64_tr_b16 v[170:171], v14 offset:8448
  v_mfma_f32_16x16x32_bf16 v[72:75], v[176:179], v[140:143], v[72:75]
  ds_read_b128 v[120:123], v7 offset:2048
  v_mfma_f32_16x16x32_bf16 v[76:79], v[180:183], v[140:143], v[76:79]
  ds_read_b128 v[124:127], v7 offset:4096
  v_mfma_f32_16x16x32_bf16 v[80:83], v[184:187], v[140:143], v[80:83]
  ds_read_b128 v[128:131], v7 offset:6144
  v_mfma_f32_16x16x32_bf16 v[84:87], v[140:143], v[188:191], v[84:87]
  v_mfma_f32_16x16x32_bf16 v[88:91], v[140:143], v[192:195], v[88:91]
  v_mfma_f32_16x16x32_bf16 v[92:95], v[172:175], v[144:147], v[92:95]
  v_mfma_f32_16x16x32_bf16 v[96:99], v[176:179], v[144:147], v[96:99]
  v_mfma_f32_16x16x32_bf16 v[100:103], v[180:183], v[144:147], v[100:103]
  v_mfma_f32_16x16x32_bf16 v[104:107], v[184:187], v[144:147], v[104:107]
  v_mfma_f32_16x16x32_bf16 v[108:111], v[144:147], v[188:191], v[108:111]
  v_mfma_f32_16x16x32_bf16 v[112:115], v[144:147], v[192:195], v[112:115]
  s_waitcnt lgkmcnt(0)
  v_mfma_f32_16x16x32_bf16 v[20:23], v[148:151], v[116:119], v[20:23]
  ds_read_b128 v[132:135], v8 offset:0
  v_mfma_f32_16x16x32_bf16 v[24:27], v[152:155], v[116:119], v[24:27]
  ds_read_b64_tr_b16 v[172:173], v13 offset:2048
  v_mfma_f32_16x16x32_bf16 v[28:31], v[156:159], v[116:119], v[28:31]
  ds_read_b64_tr_b16 v[174:175], v13 offset:2304
  v_mfma_f32_16x16x32_bf16 v[32:35], v[160:163], v[116:119], v[32:35]
  ds_read_b64_tr_b16 v[176:177], v14 offset:2048
  v_mfma_f32_16x16x32_bf16 v[36:39], v[116:119], v[164:167], v[36:39]
  ds_read_b64_tr_b16 v[178:179], v14 offset:2304
  v_mfma_f32_16x16x32_bf16 v[40:43], v[116:119], v[168:171], v[40:43]
  ds_read_b64_tr_b16 v[180:181], v13 offset:6144
  v_mfma_f32_16x16x32_bf16 v[44:47], v[148:151], v[120:123], v[44:47]
  ds_read_b64_tr_b16 v[182:183], v13 offset:6400
  v_mfma_f32_16x16x32_bf16 v[48:51], v[152:155], v[120:123], v[48:51]
  ds_read_b64_tr_b16 v[184:185], v14 offset:6144
  v_mfma_f32_16x16x32_bf16 v[52:55], v[156:159], v[120:123], v[52:55]
  ds_read_b64_tr_b16 v[186:187], v14 offset:6400
  v_mfma_f32_16x16x32_bf16 v[56:59], v[160:163], v[120:123], v[56:59]
  ds_read_b64_tr_b16 v[188:189], v13 offset:10240
  v_mfma_f32_16x16x32_bf16 v[60:63], v[120:123], v[164:167], v[60:63]
  ds_read_b64_tr_b16 v[190:191], v13 offset:10496
  v_mfma_f32_16x16x32_bf16 v[64:67], v[120:123], v[168:171], v[64:67]
  ds_read_b64_tr_b16 v[192:193], v14 offset:10240
  v_mfma_f32_16x16x32_bf16 v[68:71], v[148:151], v[124:127], v[68:71]
  ds_read_b64_tr_b16 v[194:195], v14 offset:10496
  v_mfma_f32_16x16x32_bf16 v[72:75], v[152:155], v[124:127], v[72:75]
  ds_read_b128 v[136:139], v8 offset:2048
  v_mfma_f32_16x16x32_bf16 v[76:79], v[156:159], v[124:127], v[76:79]
  ds_read_b128 v[140:143], v8 offset:4096
  v_mfma_f32_16x16x32_bf16 v[80:83], v[160:163], v[124:127], v[80:83]
  ds_read_b128 v[144:147], v8 offset:6144
  v_mfma_f32_16x16x32_bf16 v[84:87], v[124:127], v[164:167], v[84:87]
  v_mfma_f32_16x16x32_bf16 v[88:91], v[124:127], v[168:171], v[88:91]
  v_mfma_f32_16x16x32_bf16 v[92:95], v[148:151], v[128:131], v[92:95]
  v_mfma_f32_16x16x32_bf16 v[96:99], v[152:155], v[128:131], v[96:99]
  v_mfma_f32_16x16x32_bf16 v[100:103], v[156:159], v[128:131], v[100:103]
  v_mfma_f32_16x16x32_bf16 v[104:107], v[160:163], v[128:131], v[104:107]
  v_mfma_f32_16x16x32_bf16 v[108:111], v[128:131], v[164:167], v[108:111]
  v_mfma_f32_16x16x32_bf16 v[112:115], v[128:131], v[168:171], v[112:115]
  s_waitcnt lgkmcnt(0)
  s_barrier
  v_mfma_f32_16x16x32_bf16 v[20:23], v[172:175], v[132:135], v[20:23]
  ds_read_b128 v[116:119], v9 offset:0
  v_mfma_f32_16x16x32_bf16 v[24:27], v[176:179], v[132:135], v[24:27]
  ds_read_b64_tr_b16 v[148:149], v15 offset:0
  v_mfma_f32_16x16x32_bf16 v[28:31], v[180:183], v[132:135], v[28:31]
  ds_read_b64_tr_b16 v[150:151], v15 offset:256
  v_mfma_f32_16x16x32_bf16 v[32:35], v[184:187], v[132:135], v[32:35]
  ds_read_b64_tr_b16 v[152:153], v16 offset:0
  v_mfma_f32_16x16x32_bf16 v[36:39], v[132:135], v[188:191], v[36:39]
  ds_read_b64_tr_b16 v[154:155], v16 offset:256
  v_mfma_f32_16x16x32_bf16 v[40:43], v[132:135], v[192:195], v[40:43]
  ds_read_b64_tr_b16 v[156:157], v15 offset:4096
  v_mfma_f32_16x16x32_bf16 v[44:47], v[172:175], v[136:139], v[44:47]
  ds_read_b64_tr_b16 v[158:159], v15 offset:4352
  v_mfma_f32_16x16x32_bf16 v[48:51], v[176:179], v[136:139], v[48:51]
  ds_read_b64_tr_b16 v[160:161], v16 offset:4096
  v_mfma_f32_16x16x32_bf16 v[52:55], v[180:183], v[136:139], v[52:55]
  ds_read_b64_tr_b16 v[162:163], v16 offset:4352
  v_mfma_f32_16x16x32_bf16 v[56:59], v[184:187], v[136:139], v[56:59]
  ds_read_b64_tr_b16 v[164:165], v15 offset:8192
  v_mfma_f32_16x16x32_bf16 v[60:63], v[136:139], v[188:191], v[60:63]
  ds_read_b64_tr_b16 v[166:167], v15 offset:8448
  v_mfma_f32_16x16x32_bf16 v[64:67], v[136:139], v[192:195], v[64:67]
  ds_read_b64_tr_b16 v[168:169], v16 offset:8192
  v_mfma_f32_16x16x32_bf16 v[68:71], v[172:175], v[140:143], v[68:71]
  ds_read_b64_tr_b16 v[170:171], v16 offset:8448
  v_mfma_f32_16x16x32_bf16 v[72:75], v[176:179], v[140:143], v[72:75]
  ds_read_b128 v[120:123], v9 offset:2048
  v_mfma_f32_16x16x32_bf16 v[76:79], v[180:183], v[140:143], v[76:79]
  ds_read_b128 v[124:127], v9 offset:4096
  v_mfma_f32_16x16x32_bf16 v[80:83], v[184:187], v[140:143], v[80:83]
  ds_read_b128 v[128:131], v9 offset:6144
  v_mfma_f32_16x16x32_bf16 v[84:87], v[140:143], v[188:191], v[84:87]
  v_mfma_f32_16x16x32_bf16 v[88:91], v[140:143], v[192:195], v[88:91]
  v_mfma_f32_16x16x32_bf16 v[92:95], v[172:175], v[144:147], v[92:95]
  v_mfma_f32_16x16x32_bf16 v[96:99], v[176:179], v[144:147], v[96:99]
  v_mfma_f32_16x16x32_bf16 v[100:103], v[180:183], v[144:147], v[100:103]
  v_mfma_f32_16x16x32_bf16 v[104:107], v[184:187], v[144:147], v[104:107]
  v_mfma_f32_16x16x32_bf16 v[108:111], v[144:147], v[188:191], v[108:111]
  v_mfma_f32_16x16x32_bf16 v[112:115], v[144:147], v[192:195], v[112:115]
  s_waitcnt lgkmcnt(0)
  v_mfma_f32_16x16x32_bf16 v[20:23], v[148:151], v[116:119], v[20:23]
  ds_read_b128 v[132:135], v10 offset:0
  v_mfma_f32_16x16x32_bf16 v[24:27], v[152:155], v[116:119], v[24:27]
  ds_read_b64_tr_b16 v[172:173], v15 offset:2048
  v_mfma_f32_16x16x32_bf16 v[28:31], v[156:159], v[116:119], v[28:31]
  ds_read_b64_tr_b16 v[174:175], v15 offset:2304
  v_mfma_f32_16x16x32_bf16 v[32:35], v[160:163], v[116:119], v[32:35]
  ds_read_b64_tr_b16 v[176:177], v16 offset:2048
  v_mfma_f32_16x16x32_bf16 v[36:39], v[116:119], v[164:167], v[36:39]
  ds_read_b64_tr_b16 v[178:179], v16 offset:2304
  v_mfma_f32_16x16x32_bf16 v[40:43], v[116:119], v[168:171], v[40:43]
  ds_read_b64_tr_b16 v[180:181], v15 offset:6144
  v_mfma_f32_16x16x32_bf16 v[44:47], v[148:151], v[120:123], v[44:47]
  ds_read_b64_tr_b16 v[182:183], v15 offset:6400
  v_mfma_f32_16x16x32_bf16 v[48:51], v[152:155], v[120:123], v[48:51]
  ds_read_b64_tr_b16 v[184:185], v16 offset:6144
  v_mfma_f32_16x16x32_bf16 v[52:55], v[156:159], v[120:123], v[52:55]
  ds_read_b64_tr_b16 v[186:187], v16 offset:6400
  v_mfma_f32_16x16x32_bf16 v[56:59], v[160:163], v[120:123], v[56:59]
  ds_read_b64_tr_b16 v[188:189], v15 offset:10240
  v_mfma_f32_16x16x32_bf16 v[60:63], v[120:123], v[164:167], v[60:63]
  ds_read_b64_tr_b16 v[190:191], v15 offset:10496
  v_mfma_f32_16x16x32_bf16 v[64:67], v[120:123], v[168:171], v[64:67]
  ds_read_b64_tr_b16 v[192:193], v16 offset:10240
  v_mfma_f32_16x16x32_bf16 v[68:71], v[148:151], v[124:127], v[68:71]
  ds_read_b64_tr_b16 v[194:195], v16 offset:10496
  v_mfma_f32_16x16x32_bf16 v[72:75], v[152:155], v[124:127], v[72:75]
  ds_read_b128 v[136:139], v10 offset:2048
  v_mfma_f32_16x16x32_bf16 v[76:79], v[156:159], v[124:127], v[76:79]
  ds_read_b128 v[140:143], v10 offset:4096
  v_mfma_f32_16x16x32_bf16 v[80:83], v[160:163], v[124:127], v[80:83]
  ds_read_b128 v[144:147], v10 offset:6144
  v_mfma_f32_16x16x32_bf16 v[84:87], v[124:127], v[164:167], v[84:87]
  v_mfma_f32_16x16x32_bf16 v[88:91], v[124:127], v[168:171], v[88:91]
  v_mfma_f32_16x16x32_bf16 v[92:95], v[148:151], v[128:131], v[92:95]
  v_mfma_f32_16x16x32_bf16 v[96:99], v[152:155], v[128:131], v[96:99]
  v_mfma_f32_16x16x32_bf16 v[100:103], v[156:159], v[128:131], v[100:103]
  v_mfma_f32_16x16x32_bf16 v[104:107], v[160:163], v[128:131], v[104:107]
  v_mfma_f32_16x16x32_bf16 v[108:111], v[128:131], v[164:167], v[108:111]
  v_mfma_f32_16x16x32_bf16 v[112:115], v[128:131], v[168:171], v[112:115]
  s_waitcnt lgkmcnt(0)
  v_mfma_f32_16x16x32_bf16 v[20:23], v[172:175], v[132:135], v[20:23]
  v_mfma_f32_16x16x32_bf16 v[24:27], v[176:179], v[132:135], v[24:27]
  v_mfma_f32_16x16x32_bf16 v[28:31], v[180:183], v[132:135], v[28:31]
  v_mfma_f32_16x16x32_bf16 v[32:35], v[184:187], v[132:135], v[32:35]
  v_mfma_f32_16x16x32_bf16 v[36:39], v[132:135], v[188:191], v[36:39]
  v_mfma_f32_16x16x32_bf16 v[40:43], v[132:135], v[192:195], v[40:43]
  v_mfma_f32_16x16x32_bf16 v[44:47], v[172:175], v[136:139], v[44:47]
  v_mfma_f32_16x16x32_bf16 v[48:51], v[176:179], v[136:139], v[48:51]
  v_mfma_f32_16x16x32_bf16 v[52:55], v[180:183], v[136:139], v[52:55]
  v_mfma_f32_16x16x32_bf16 v[56:59], v[184:187], v[136:139], v[56:59]
  v_mfma_f32_16x16x32_bf16 v[60:63], v[136:139], v[188:191], v[60:63]
  v_mfma_f32_16x16x32_bf16 v[64:67], v[136:139], v[192:195], v[64:67]
  v_mfma_f32_16x16x32_bf16 v[68:71], v[172:175], v[140:143], v[68:71]
  v_mfma_f32_16x16x32_bf16 v[72:75], v[176:179], v[140:143], v[72:75]
  v_mfma_f32_16x16x32_bf16 v[76:79], v[180:183], v[140:143], v[76:79]
  v_mfma_f32_16x16x32_bf16 v[80:83], v[184:187], v[140:143], v[80:83]
  v_mfma_f32_16x16x32_bf16 v[84:87], v[140:143], v[188:191], v[84:87]
  v_mfma_f32_16x16x32_bf16 v[88:91], v[140:143], v[192:195], v[88:91]
  v_mfma_f32_16x16x32_bf16 v[92:95], v[172:175], v[144:147], v[92:95]
  v_mfma_f32_16x16x32_bf16 v[96:99], v[176:179], v[144:147], v[96:99]
  v_mfma_f32_16x16x32_bf16 v[100:103], v[180:183], v[144:147], v[100:103]
  v_mfma_f32_16x16x32_bf16 v[104:107], v[184:187], v[144:147], v[104:107]
  v_mfma_f32_16x16x32_bf16 v[108:111], v[144:147], v[188:191], v[108:111]
  v_mfma_f32_16x16x32_bf16 v[112:115], v[144:147], v[192:195], v[112:115]
  s_waitcnt vmcnt(0)
  s_barrier
  s_nop 7
  v_mov_b32 v4, 0
  buffer_load_dwordx2 v[250:251], v4, s[96:99], 0 offen sc1
  s_lshl_b32 s36, s95, 18
  s_lshl_b32 s37, s23, 14
  s_add_u32 s60, s36, s37
  s_lshl_b32 s37, s20, 12
  s_add_u32 s60, s60, s37
  s_add_u32 s60, s60, 4194304
  s_mov_b32 s52, 0x3eb8aa3b
  s_lshl_b32 s37, s20, 11
  v_add_u32 v2, s37, v6
  v_add_u32 v3, s37, v19
  v_add_u32 v5, 131072, v2
  v_cvt_pk_bf16_f32 v216, v28, v29
  v_cvt_pk_bf16_f32 v217, v30, v31
  v_cvt_pk_bf16_f32 v218, v52, v53
  v_cvt_pk_bf16_f32 v219, v54, v55
  s_nop 1
  v_permlane16_swap_b32 v216, v218
  v_permlane16_swap_b32 v217, v219
  s_add_u32 s44, s60, 0
  buffer_store_dwordx4 v[216:219], v248, s[12:15], s44 offen sc1
  ds_write_b128 v2, v[216:219] offset:0
  v_cvt_pk_bf16_f32 v220, v32, v33
  v_cvt_pk_bf16_f32 v221, v34, v35
  v_cvt_pk_bf16_f32 v222, v56, v57
  v_cvt_pk_bf16_f32 v223, v58, v59
  s_nop 1
  v_permlane16_swap_b32 v220, v222
  v_permlane16_swap_b32 v221, v223
  s_add_u32 s44, s60, 131072
  buffer_store_dwordx4 v[220:223], v248, s[12:15], s44 offen sc1
  ds_write_b128 v2, v[220:223] offset:32768
  v_cvt_pk_bf16_f32 v224, v36, v37
  v_cvt_pk_bf16_f32 v225, v38, v39
  v_cvt_pk_bf16_f32 v226, v60, v61
  v_cvt_pk_bf16_f32 v227, v62, v63
  s_nop 1
  v_permlane16_swap_b32 v224, v226
  v_permlane16_swap_b32 v225, v227
  s_add_u32 s44, s60, 1024
  buffer_store_dwordx4 v[224:227], v249, s[12:15], s44 offen sc1
  ds_write_b128 v3, v[224:227] offset:0
  v_cvt_pk_bf16_f32 v228, v40, v41
  v_cvt_pk_bf16_f32 v229, v42, v43
  v_cvt_pk_bf16_f32 v230, v64, v65
  v_cvt_pk_bf16_f32 v231, v66, v67
  s_nop 1
  v_permlane16_swap_b32 v228, v230
  v_permlane16_swap_b32 v229, v231
  s_add_u32 s44, s60, 132096
  buffer_store_dwordx4 v[228:231], v249, s[12:15], s44 offen sc1
  ds_write_b128 v3, v[228:231] offset:32768
  v_cvt_pk_bf16_f32 v232, v76, v77
  v_cvt_pk_bf16_f32 v233, v78, v79
  v_cvt_pk_bf16_f32 v234, v100, v101
  v_cvt_pk_bf16_f32 v235, v102, v103
  s_nop 1
  v_permlane16_swap_b32 v232, v234
  v_permlane16_swap_b32 v233, v235
  s_add_u32 s44, s60, 2048
  buffer_store_dwordx4 v[232:235], v248, s[12:15], s44 offen sc1
  ds_write_b128 v2, v[232:235] offset:1024
  v_cvt_pk_bf16_f32 v236, v80, v81
  v_cvt_pk_bf16_f32 v237, v82, v83
  v_cvt_pk_bf16_f32 v238, v104, v105
  v_cvt_pk_bf16_f32 v239, v106, v107
  s_nop 1
  v_permlane16_swap_b32 v236, v238
  v_permlane16_swap_b32 v237, v239
  s_add_u32 s44, s60, 133120
  buffer_store_dwordx4 v[236:239], v248, s[12:15], s44 offen sc1
  ds_write_b128 v2, v[236:239] offset:33792
  v_cvt_pk_bf16_f32 v240, v84, v85
  v_cvt_pk_bf16_f32 v241, v86, v87
  v_cvt_pk_bf16_f32 v242, v108, v109
  v_cvt_pk_bf16_f32 v243, v110, v111
  s_nop 1
  v_permlane16_swap_b32 v240, v242
  v_permlane16_swap_b32 v241, v243
  s_add_u32 s44, s60, 3072
  buffer_store_dwordx4 v[240:243], v249, s[12:15], s44 offen sc1
  ds_write_b128 v3, v[240:243] offset:1024
  v_cvt_pk_bf16_f32 v244, v88, v89
  v_cvt_pk_bf16_f32 v245, v90, v91
  v_cvt_pk_bf16_f32 v246, v112, v113
  v_cvt_pk_bf16_f32 v247, v114, v115
  s_nop 1
  v_permlane16_swap_b32 v244, v246
  v_permlane16_swap_b32 v245, v247
  s_add_u32 s44, s60, 134144
  buffer_store_dwordx4 v[244:247], v249, s[12:15], s44 offen sc1
  ds_write_b128 v3, v[244:247] offset:33792
  v_mul_f32 v20, s52, v20
  v_mul_f32 v44, s52, v44
  v_mul_f32 v21, s52, v21
  v_mul_f32 v45, s52, v45
  v_mul_f32 v22, s52, v22
  v_mul_f32 v46, s52, v46
  v_mul_f32 v23, s52, v23
  v_mul_f32 v47, s52, v47
  v_cvt_pk_bf16_f32 v148, v20, v21
  v_cvt_pk_bf16_f32 v149, v22, v23
  v_cvt_pk_bf16_f32 v150, v44, v45
  v_cvt_pk_bf16_f32 v151, v46, v47
  s_nop 1
  v_permlane16_swap_b32 v148, v150
  v_permlane16_swap_b32 v149, v151
  ds_write_b128 v5, v[148:151] offset:0
  v_mul_f32 v24, s52, v24
  v_mul_f32 v48, s52, v48
  v_mul_f32 v25, s52, v25
  v_mul_f32 v49, s52, v49
  v_mul_f32 v26, s52, v26
  v_mul_f32 v50, s52, v50
  v_mul_f32 v27, s52, v27
  v_mul_f32 v51, s52, v51
  v_cvt_pk_bf16_f32 v152, v24, v25
  v_cvt_pk_bf16_f32 v153, v26, v27
  v_cvt_pk_bf16_f32 v154, v48, v49
  v_cvt_pk_bf16_f32 v155, v50, v51
  s_nop 1
  v_permlane16_swap_b32 v152, v154
  v_permlane16_swap_b32 v153, v155
  ds_write_b128 v5, v[152:155] offset:8192
  s_nop 1
  v_mul_f32 v68, s52, v68
  v_mul_f32 v92, s52, v92
  v_mul_f32 v69, s52, v69
  v_mul_f32 v93, s52, v93
  v_mul_f32 v70, s52, v70
  v_mul_f32 v94, s52, v94
  v_mul_f32 v71, s52, v71
  v_mul_f32 v95, s52, v95
  v_cvt_pk_bf16_f32 v148, v68, v69
  v_cvt_pk_bf16_f32 v149, v70, v71
  v_cvt_pk_bf16_f32 v150, v92, v93
  v_cvt_pk_bf16_f32 v151, v94, v95
  s_nop 1
  v_permlane16_swap_b32 v148, v150
  v_permlane16_swap_b32 v149, v151
  ds_write_b128 v5, v[148:151] offset:1024
  v_mul_f32 v72, s52, v72
  v_mul_f32 v96, s52, v96
  v_mul_f32 v73, s52, v73
  v_mul_f32 v97, s52, v97
  v_mul_f32 v74, s52, v74
  v_mul_f32 v98, s52, v98
  v_mul_f32 v75, s52, v75
  v_mul_f32 v99, s52, v99
  v_cvt_pk_bf16_f32 v152, v72, v73
  v_cvt_pk_bf16_f32 v153, v74, v75
  v_cvt_pk_bf16_f32 v154, v96, v97
  v_cvt_pk_bf16_f32 v155, v98, v99
  s_nop 1
  v_permlane16_swap_b32 v152, v154
  v_permlane16_swap_b32 v153, v155
  ds_write_b128 v5, v[152:155] offset:9216
  s_nop 1
gated_mix__mha_block__mha_block__prompt_kernel_p1_end:
  v_lshlrev_b32 v5, 4, v1
  v_mov_b32 v10, 0
  s_lshl_b32 s36, s20, 11
  v_add_u32 v12, s36, v5
  v_add_u32 v12, 131072, v12
  s_lshr_b32 s49, s20, 2
  s_and_b32 s50, s20, 3
  s_lshl_b32 s36, s49, 15
  v_add_u32 v6, s36, v5
  s_mov_b32 s44, 0xffff
  s_mov_b32 s45, 0xffff
  s_mov_b32 s62, -1
  s_mov_b32 s63, 0xff
  s_lshl_b32 s46, s95, 1
  s_add_u32 s46, s46, s49
  s_lshl_b32 s46, s46, 17
  s_add_u32 s46, s46, 4194304
  s_lshl_b32 s47, s50, 11
  s_add_u32 s47, s47, s36
  s_lshl_b32 s51, s23, 3
  s_lshl_b32 s37, s50, 1
  s_add_u32 s51, s51, s37
  v_lshrrev_b32 v2, 5, v1
  v_lshlrev_b32 v2, 8, v2
  v_and_b32 v3, 15, v1
  v_lshl_add_u32 v8, v3, 4, v2
  v_add_u32 v7, 65536, v8
  v_add_u32 v7, s36, v7
  v_add_u32 v8, 1024, v8
  v_mov_b32 v9, 0xdddddddd
  v_and_b32 v2, 31, v1
  v_mov_b32 v3, 0x3f803f80
  v_cmp_eq_u32 vcc, 16, v2
  v_lshlrev_b32 v11, 7, v1
  s_nop 0
  v_cndmask_b32 v2, 0, v3, vcc
  v_mov_b32 v32, v2
  v_mov_b32 v33, v2
  v_mov_b32 v34, v2
  v_mov_b32 v35, v2
  v_mov_b32 v36, v2
  v_mov_b32 v37, v2
  v_mov_b32 v38, v2
  v_mov_b32 v39, v2
  v_mov_b32 v40, v2
  v_mov_b32 v41, v2
  v_mov_b32 v42, v2
  v_mov_b32 v43, v2
  v_mov_b32 v44, v2
  v_mov_b32 v45, v2
  v_mov_b32 v46, v2
  v_mov_b32 v47, v2
  v_mov_b32 v112, 0
  v_mov_b32 v113, 0
  v_mov_b32 v114, 0
  v_mov_b32 v115, 0
  v_mov_b32 v116, 0
  v_mov_b32 v117, 0
  v_mov_b32 v118, 0
  v_mov_b32 v119, 0
  v_mov_b32 v120, 0
  v_mov_b32 v121, 0
  v_mov_b32 v122, 0
  v_mov_b32 v123, 0
  v_mov_b32 v124, 0
  v_mov_b32 v125, 0
  v_mov_b32 v126, 0
  v_mov_b32 v127, 0
  v_mov_b32 v128, 0
  v_mov_b32 v129, 0
  v_mov_b32 v130, 0
  v_mov_b32 v131, 0
  v_mov_b32 v132, 0
  v_mov_b32 v133, 0
  v_mov_b32 v134, 0
  v_mov_b32 v135, 0
  v_mov_b32 v136, 0
  v_mov_b32 v137, 0
  v_mov_b32 v138, 0
  v_mov_b32 v139, 0
  v_mov_b32 v140, 0
  v_mov_b32 v141, 0
  v_mov_b32 v142, 0
  v_mov_b32 v143, 0
  s_and_b32 s36, s2, 7
  s_lshr_b32 s37, s2, 3
  s_lshl_b32 s54, s36, 2
  s_lshr_b32 s38, s37, 3
  s_add_u32 s54, s54, s38
  s_and_b32 s55, s37, 7
  v_lshrrev_b32 v2, 3, v1
  v_lshlrev_b32 v3, 10, v2
  v_and_b32 v4, 7, v1
  v_bfe_u32 v2, v1, 4, 1
  v_lshlrev_b32 v2, 2, v2
  v_xor_b32 v4, v4, v2
  v_lshl_add_u32 v152, v4, 4, v3
  s_cmp_lt_u32 s20, 4
  s_cselect_b32 s36, s28, s88
  s_cselect_b32 s37, s29, s89
  s_mov_b32 s4, s36
  s_and_b32 s5, s37, 0xffff
  s_mov_b32 s6, 524288
  s_mov_b32 s7, 0x20000
  s_bfe_u32 s36, s20, 0x10001
  s_lshl_b32 s56, s36, 16
  s_and_b32 s37, s20, 1
  s_lshl_b32 s38, s37, 15
  s_add_u32 s56, s56, s38
  s_lshl_b32 s38, s55, 7
  s_add_u32 s56, s56, s38
  s_lshl_b32 s37, s37, 12
  s_lshr_b32 s38, s20, 1
  s_lshl_b32 s38, s38, 13
  s_add_u32 s57, s38, s37
  s_add_u32 s57, s57, 131072
  s_lshr_b32 s38, s20, 2
  s_lshl_b32 s38, s38, 16
  s_lshl_b32 s36, s36, 15
  s_add_u32 s58, s38, s36
  s_add_u32 s58, s58, s37
  s_cmp_lt_u32 s20, 4
  s_cbranch_scc1 gated_mix__mha_block__mha_block__prompt_kernel_joinB
  s_barrier
gated_mix__mha_block__mha_block__prompt_kernel_joinB:
  s_waitcnt lgkmcnt(0)
  s_barrier
  ds_read_b128 v[16:19], v12
  ds_read_b128 v[20:23], v12 offset:1024
  s_waitcnt vmcnt(0)
  s_mov_b32 s100, 0
gated_mix__mha_block__mha_block__prompt_kernel_nonce_loop:
  v_readfirstlane_b32 s36, v251
  v_readfirstlane_b32 s94, v250
  s_nop 3
  s_cmp_eq_u32 s36, 1
  s_cbranch_scc1 gated_mix__mha_block__mha_block__prompt_kernel_nonce_ok
  s_add_u32 s100, s100, 1
  s_cmp_gt_u32 s100, 200000
  s_cbranch_scc1 gated_mix__mha_block__mha_block__prompt_kernel_nonce_ok
  s_sleep 1
  buffer_load_dwordx2 v[250:251], v10, s[96:99], 0 offen sc1
  s_waitcnt vmcnt(0)
  s_branch gated_mix__mha_block__mha_block__prompt_kernel_nonce_loop
gated_mix__mha_block__mha_block__prompt_kernel_nonce_ok:
  s_cmp_gt_u32 s20, 4
  s_cbranch_scc1 gated_mix__mha_block__mha_block__prompt_kernel_nopub
  s_lshl_b32 s36, s95, 3
  s_add_u32 s36, s36, s23
  s_mul_i32 s36, s36, 5
  s_add_u32 s36, s36, s20
  s_lshl_b32 s36, s36, 7
  s_add_u32 s36, s36, 22020096
  v_mov_b32 v250, s94
  s_mov_b64 exec, 1
  buffer_store_dword v250, v10, s[12:15], s36 offen sc1
  s_mov_b64 exec, -1
gated_mix__mha_block__mha_block__prompt_kernel_nopub:
  ds_read_b128 v[24:27], v6 offset:0
  ds_read_b128 v[28:31], v6 offset:1024
  s_mov_b64 exec, s[44:45]
  ds_read_b128 v[32:35], v7 offset:0
  ds_read_b128 v[36:39], v7 offset:512
  s_mov_b64 exec, -1
  s_waitcnt lgkmcnt(0)
  v_mfma_f32_32x32x16_bf16 v[80:95], v[24:27], v[16:19], 0
  v_mfma_f32_32x32x16_bf16 v[96:111], v[24:27], v[20:23], 0
  s_nop 15
  s_nop 3
  v_max3_f32 v2, v80, v81, v82
  v_max3_f32 v2, v2, v83, v84
  v_max3_f32 v2, v2, v85, v86
  v_max3_f32 v2, v2, v87, v88
  v_max3_f32 v2, v2, v89, v90
  v_max3_f32 v2, v2, v91, v92
  v_max3_f32 v2, v2, v93, v94
  v_max_f32 v2, v2, v95
  v_max3_f32 v4, v96, v97, v98
  v_max3_f32 v4, v4, v99, v100
  v_max3_f32 v4, v4, v101, v102
  v_max3_f32 v4, v4, v103, v104
  v_max3_f32 v4, v4, v105, v106
  v_max3_f32 v4, v4, v107, v108
  v_max3_f32 v4, v4, v109, v110
  v_max_f32 v4, v4, v111
  v_mov_b32 v3, v2
  s_nop 1
  v_permlane32_swap_b32 v2, v3
  s_nop 1
  v_max_f32 v2, v2, v3
  v_sub_f32 v2, 0, v2
  v_mov_b32 v48, v2
  v_mov_b32 v49, v2
  v_mov_b32 v50, v2
  v_mov_b32 v51, v2
  v_mov_b32 v52, v2
  v_mov_b32 v53, v2
  v_mov_b32 v54, v2
  v_mov_b32 v55, v2
  v_mov_b32 v56, v2
  v_mov_b32 v57, v2
  v_mov_b32 v58, v2
  v_mov_b32 v59, v2
  v_mov_b32 v60, v2
  v_mov_b32 v61, v2
  v_mov_b32 v62, v2
  v_mov_b32 v63, v2
  v_mov_b32 v3, v4
  s_nop 1
  v_permlane32_swap_b32 v4, v3
  s_nop 1
  v_max_f32 v4, v4, v3
  v_sub_f32 v4, 0, v4
  v_mov_b32 v64, v4
  v_mov_b32 v65, v4
  v_mov_b32 v66, v4
  v_mov_b32 v67, v4
  v_mov_b32 v68, v4
  v_mov_b32 v69, v4
  v_mov_b32 v70, v4
  v_mov_b32 v71, v4
  v_mov_b32 v72, v4
  v_mov_b32 v73, v4
  v_mov_b32 v74, v4
  v_mov_b32 v75, v4
  v_mov_b32 v76, v4
  v_mov_b32 v77, v4
  v_mov_b32 v78, v4
  v_mov_b32 v79, v4
  s_nop 1
  v_mfma_f32_32x32x16_bf16 v[80:95], v[24:27], v[16:19], v[48:63]
  s_nop 7
  s_nop 3
  v_exp_f32 v80, v80
  v_exp_f32 v81, v81
  v_exp_f32 v82, v82
  v_exp_f32 v83, v83
  v_exp_f32 v84, v84
  v_exp_f32 v85, v85
  v_mfma_f32_32x32x16_bf16 v[96:111], v[24:27], v[20:23], v[64:79]
  v_exp_f32 v86, v86
  v_exp_f32 v87, v87
  v_exp_f32 v88, v88
  v_exp_f32 v89, v89
  v_exp_f32 v90, v90
  v_smfmac_f32_32x32x32_bf16 v[112:127], v[32:35], v[80:87], v9
  s_mov_b64 exec, s[44:45]
  ds_read_b128 v[40:43], v7 offset:1024
  ds_read_b128 v[44:47], v7 offset:1536
  s_mov_b64 exec, -1
  ds_read_b128 v[24:27], v6 offset:2048
  v_exp_f32 v91, v91
  v_exp_f32 v92, v92
  v_exp_f32 v93, v93
  v_exp_f32 v94, v94
  v_exp_f32 v95, v95
  v_exp_f32 v96, v96
  v_exp_f32 v97, v97
  v_exp_f32 v98, v98
  v_smfmac_f32_32x32x32_bf16 v[112:127], v[36:39], v[88:95], v9
  v_exp_f32 v99, v99
  v_exp_f32 v100, v100
  v_exp_f32 v101, v101
  v_mfma_f32_32x32x16_bf16 v[80:95], v[28:31], v[16:19], v[48:63]
  v_exp_f32 v102, v102
  v_exp_f32 v103, v103
  v_exp_f32 v104, v104
  v_exp_f32 v105, v105
  v_exp_f32 v106, v106
  v_smfmac_f32_32x32x32_bf16 v[128:143], v[32:35], v[96:103], v9
  s_waitcnt lgkmcnt(0)
  v_exp_f32 v107, v107
  v_exp_f32 v108, v108
  v_exp_f32 v109, v109
  v_exp_f32 v110, v110
  v_exp_f32 v111, v111
  v_exp_f32 v80, v80
  v_exp_f32 v81, v81
  v_exp_f32 v82, v82
  v_smfmac_f32_32x32x32_bf16 v[128:143], v[36:39], v[104:111], v9
  v_exp_f32 v83, v83
  v_exp_f32 v84, v84
  v_exp_f32 v85, v85
  v_mfma_f32_32x32x16_bf16 v[96:111], v[28:31], v[20:23], v[64:79]
  v_exp_f32 v86, v86
  v_exp_f32 v87, v87
  v_exp_f32 v88, v88
  v_exp_f32 v89, v89
  v_exp_f32 v90, v90
  v_smfmac_f32_32x32x32_bf16 v[112:127], v[40:43], v[80:87], v9
  s_mov_b64 exec, s[44:45]
  ds_read_b128 v[32:35], v7 offset:2048
  ds_read_b128 v[36:39], v7 offset:2560
  s_mov_b64 exec, -1
  ds_read_b128 v[28:31], v6 offset:3072
  v_exp_f32 v91, v91
  v_exp_f32 v92, v92
  v_exp_f32 v93, v93
  v_exp_f32 v94, v94
  v_exp_f32 v95, v95
  v_exp_f32 v96, v96
  v_exp_f32 v97, v97
  v_exp_f32 v98, v98
  v_smfmac_f32_32x32x32_bf16 v[112:127], v[44:47], v[88:95], v9
  v_exp_f32 v99, v99
  v_exp_f32 v100, v100
  v_exp_f32 v101, v101
  v_mfma_f32_32x32x16_bf16 v[80:95], v[24:27], v[16:19], v[48:63]
  v_exp_f32 v102, v102
  v_exp_f32 v103, v103
  v_exp_f32 v104, v104
  v_exp_f32 v105, v105
  v_exp_f32 v106, v106
  v_smfmac_f32_32x32x32_bf16 v[128:143], v[40:43], v[96:103], v9
  s_waitcnt lgkmcnt(0)
  s_mul_i32 s36, s95, 5120
  s_add_u32 s36, s36, 22020096
  s_mov_b64 exec, s[62:63]
  buffer_load_dword v251, v11, s[12:15], s36 offen sc1
  s_mov_b64 exec, -1
  v_exp_f32 v107, v107
  v_exp_f32 v108, v108
  v_exp_f32 v109, v109
  v_exp_f32 v110, v110
  v_exp_f32 v111, v111
  v_exp_f32 v80, v80
  v_exp_f32 v81, v81
  v_exp_f32 v82, v82
  v_smfmac_f32_32x32x32_bf16 v[128:143], v[44:47], v[104:111], v9
  v_exp_f32 v83, v83
  v_exp_f32 v84, v84
  v_exp_f32 v85, v85
  v_mfma_f32_32x32x16_bf16 v[96:111], v[24:27], v[20:23], v[64:79]
  v_exp_f32 v86, v86
  v_exp_f32 v87, v87
  v_exp_f32 v88, v88
  v_exp_f32 v89, v89
  v_exp_f32 v90, v90
  v_smfmac_f32_32x32x32_bf16 v[112:127], v[32:35], v[80:87], v9
  s_mov_b64 exec, s[44:45]
  ds_read_b128 v[40:43], v7 offset:3072
  ds_read_b128 v[44:47], v7 offset:3584
  s_mov_b64 exec, -1
  ds_read_b128 v[24:27], v6 offset:4096
  v_exp_f32 v91, v91
  v_exp_f32 v92, v92
  v_exp_f32 v93, v93
  v_exp_f32 v94, v94
  v_exp_f32 v95, v95
  v_exp_f32 v96, v96
  v_exp_f32 v97, v97
  v_exp_f32 v98, v98
  v_smfmac_f32_32x32x32_bf16 v[112:127], v[36:39], v[88:95], v9
  v_exp_f32 v99, v99
  v_exp_f32 v100, v100
  v_exp_f32 v101, v101
  v_mfma_f32_32x32x16_bf16 v[80:95], v[28:31], v[16:19], v[48:63]
  v_exp_f32 v102, v102
  v_exp_f32 v103, v103
  v_exp_f32 v104, v104
  v_exp_f32 v105, v105
  v_exp_f32 v106, v106
  v_smfmac_f32_32x32x32_bf16 v[128:143], v[32:35], v[96:103], v9
  s_waitcnt lgkmcnt(0)
  v_exp_f32 v107, v107
  v_exp_f32 v108, v108
  v_exp_f32 v109, v109
  v_exp_f32 v110, v110
  v_exp_f32 v111, v111
  v_exp_f32 v80, v80
  v_exp_f32 v81, v81
  v_exp_f32 v82, v82
  v_smfmac_f32_32x32x32_bf16 v[128:143], v[36:39], v[104:111], v9
  v_exp_f32 v83, v83
  v_exp_f32 v84, v84
  v_exp_f32 v85, v85
  v_mfma_f32_32x32x16_bf16 v[96:111], v[28:31], v[20:23], v[64:79]
  v_exp_f32 v86, v86
  v_exp_f32 v87, v87
  v_exp_f32 v88, v88
  v_exp_f32 v89, v89
  v_exp_f32 v90, v90
  v_smfmac_f32_32x32x32_bf16 v[112:127], v[40:43], v[80:87], v9
gated_mix__mha_block__mha_block__prompt_kernel_poll1:
  s_waitcnt vmcnt(0)
  s_mov_b64 exec, s[62:63]
  v_cmp_ne_u32 vcc, s94, v251
  s_nop 1
  s_cmp_eq_u64 vcc, 0
  s_cbranch_scc1 gated_mix__mha_block__mha_block__prompt_kernel_poll1_ok
  s_add_u32 s100, s100, 1
  s_cmp_gt_u32 s100, 200000
  s_cbranch_scc1 gated_mix__mha_block__mha_block__prompt_kernel_poll1_ok
  s_sleep 1
  buffer_load_dword v251, v11, s[12:15], s36 offen sc1
  s_branch gated_mix__mha_block__mha_block__prompt_kernel_poll1
gated_mix__mha_block__mha_block__prompt_kernel_poll1_ok:
  s_mov_b64 exec, -1
  s_add_u32 s48, s51, 8
  s_and_b32 s48, s48, 63
  s_lshl_b32 s48, s48, 11
  s_add_u32 s48, s48, s46
  s_add_u32 m0, s47, 8192
  s_add_u32 s39, s48, 1024
  buffer_load_dwordx4 v5, s[12:15], s48 offen sc1 lds
  s_add_u32 m0, s47, 73728
  s_nop 0
  buffer_load_dwordx4 v5, s[12:15], s39 offen sc1 lds
  s_add_u32 s48, s51, 9
  s_and_b32 s48, s48, 63
  s_lshl_b32 s48, s48, 11
  s_add_u32 s48, s48, s46
  s_add_u32 m0, s47, 9216
  s_add_u32 s39, s48, 1024
  buffer_load_dwordx4 v5, s[12:15], s48 offen sc1 lds
  s_add_u32 m0, s47, 74752
  s_nop 0
  buffer_load_dwordx4 v5, s[12:15], s39 offen sc1 lds
  s_mov_b64 exec, s[44:45]
  ds_read_b128 v[32:35], v7 offset:4096
  ds_read_b128 v[36:39], v7 offset:4608
  s_mov_b64 exec, -1
  ds_read_b128 v[28:31], v6 offset:5120
  v_exp_f32 v91, v91
  v_exp_f32 v92, v92
  v_exp_f32 v93, v93
  v_exp_f32 v94, v94
  v_exp_f32 v95, v95
  v_exp_f32 v96, v96
  v_exp_f32 v97, v97
  v_exp_f32 v98, v98
  v_smfmac_f32_32x32x32_bf16 v[112:127], v[44:47], v[88:95], v9
  v_exp_f32 v99, v99
  v_exp_f32 v100, v100
  v_exp_f32 v101, v101
  v_mfma_f32_32x32x16_bf16 v[80:95], v[24:27], v[16:19], v[48:63]
  v_exp_f32 v102, v102
  v_exp_f32 v103, v103
  v_exp_f32 v104, v104
  v_exp_f32 v105, v105
  v_exp_f32 v106, v106
  v_smfmac_f32_32x32x32_bf16 v[128:143], v[40:43], v[96:103], v9
  s_waitcnt lgkmcnt(0)
  s_add_u32 s48, s51, 16
  s_and_b32 s48, s48, 63
  s_lshl_b32 s48, s48, 11
  s_add_u32 s48, s48, s46
  s_add_u32 m0, s47, 16384
  s_add_u32 s39, s48, 1024
  buffer_load_dwordx4 v5, s[12:15], s48 offen sc1 lds
  s_add_u32 m0, s47, 81920
  s_nop 0
  buffer_load_dwordx4 v5, s[12:15], s39 offen sc1 lds
  s_add_u32 s48, s51, 17
  s_and_b32 s48, s48, 63
  s_lshl_b32 s48, s48, 11
  s_add_u32 s48, s48, s46
  s_add_u32 m0, s47, 17408
  s_add_u32 s39, s48, 1024
  buffer_load_dwordx4 v5, s[12:15], s48 offen sc1 lds
  s_add_u32 m0, s47, 82944
  s_nop 0
  buffer_load_dwordx4 v5, s[12:15], s39 offen sc1 lds
  v_exp_f32 v107, v107
  v_exp_f32 v108, v108
  v_exp_f32 v109, v109
  v_exp_f32 v110, v110
  v_exp_f32 v111, v111
  v_exp_f32 v80, v80
  v_exp_f32 v81, v81
  v_exp_f32 v82, v82
  v_smfmac_f32_32x32x32_bf16 v[128:143], v[44:47], v[104:111], v9
  v_exp_f32 v83, v83
  v_exp_f32 v84, v84
  v_exp_f32 v85, v85
  v_mfma_f32_32x32x16_bf16 v[96:111], v[24:27], v[20:23], v[64:79]
  v_exp_f32 v86, v86
  v_exp_f32 v87, v87
  v_exp_f32 v88, v88
  v_exp_f32 v89, v89
  v_exp_f32 v90, v90
  v_smfmac_f32_32x32x32_bf16 v[112:127], v[32:35], v[80:87], v9
  s_add_u32 s48, s51, 24
  s_and_b32 s48, s48, 63
  s_lshl_b32 s48, s48, 11
  s_add_u32 s48, s48, s46
  s_add_u32 m0, s47, 24576
  s_add_u32 s39, s48, 1024
  buffer_load_dwordx4 v5, s[12:15], s48 offen sc1 lds
  s_add_u32 m0, s47, 90112
  s_nop 0
  buffer_load_dwordx4 v5, s[12:15], s39 offen sc1 lds
  s_add_u32 s48, s51, 25
  s_and_b32 s48, s48, 63
  s_lshl_b32 s48, s48, 11
  s_add_u32 s48, s48, s46
  s_add_u32 m0, s47, 25600
  s_add_u32 s39, s48, 1024
  buffer_load_dwordx4 v5, s[12:15], s48 offen sc1 lds
  s_add_u32 m0, s47, 91136
  s_nop 0
  buffer_load_dwordx4 v5, s[12:15], s39 offen sc1 lds
  s_mov_b64 exec, s[44:45]
  ds_read_b128 v[40:43], v7 offset:5120
  ds_read_b128 v[44:47], v7 offset:5632
  s_mov_b64 exec, -1
  ds_read_b128 v[24:27], v6 offset:6144
  v_exp_f32 v91, v91
  v_exp_f32 v92, v92
  v_exp_f32 v93, v93
  v_exp_f32 v94, v94
  v_exp_f32 v95, v95
  v_exp_f32 v96, v96
  v_exp_f32 v97, v97
  v_exp_f32 v98, v98
  v_smfmac_f32_32x32x32_bf16 v[112:127], v[36:39], v[88:95], v9
  v_exp_f32 v99, v99
  v_exp_f32 v100, v100
  v_exp_f32 v101, v101
  v_mfma_f32_32x32x16_bf16 v[80:95], v[28:31], v[16:19], v[48:63]
  v_exp_f32 v102, v102
  v_exp_f32 v103, v103
  v_exp_f32 v104, v104
  v_exp_f32 v105, v105
  v_exp_f32 v106, v106
  v_smfmac_f32_32x32x32_bf16 v[128:143], v[32:35], v[96:103], v9
  s_waitcnt lgkmcnt(0)
  v_exp_f32 v107, v107
  v_exp_f32 v108, v108
  v_exp_f32 v109, v109
  v_exp_f32 v110, v110
  v_exp_f32 v111, v111
  v_exp_f32 v80, v80
  v_exp_f32 v81, v81
  v_exp_f32 v82, v82
  v_smfmac_f32_32x32x32_bf16 v[128:143], v[36:39], v[104:111], v9
  v_exp_f32 v83, v83
  v_exp_f32 v84, v84
  v_exp_f32 v85, v85
  v_mfma_f32_32x32x16_bf16 v[96:111], v[28:31], v[20:23], v[64:79]
  v_exp_f32 v86, v86
  v_exp_f32 v87, v87
  v_exp_f32 v88, v88
  v_exp_f32 v89, v89
  v_exp_f32 v90, v90
  v_smfmac_f32_32x32x32_bf16 v[112:127], v[40:43], v[80:87], v9
  s_mov_b64 exec, s[44:45]
  ds_read_b128 v[32:35], v7 offset:6144
  ds_read_b128 v[36:39], v7 offset:6656
  s_mov_b64 exec, -1
  ds_read_b128 v[28:31], v6 offset:7168
  v_exp_f32 v91, v91
  v_exp_f32 v92, v92
  v_exp_f32 v93, v93
  v_exp_f32 v94, v94
  v_exp_f32 v95, v95
  v_exp_f32 v96, v96
  v_exp_f32 v97, v97
  v_exp_f32 v98, v98
  v_smfmac_f32_32x32x32_bf16 v[112:127], v[44:47], v[88:95], v9
  v_exp_f32 v99, v99
  v_exp_f32 v100, v100
  v_exp_f32 v101, v101
  v_mfma_f32_32x32x16_bf16 v[80:95], v[24:27], v[16:19], v[48:63]
  v_exp_f32 v102, v102
  v_exp_f32 v103, v103
  v_exp_f32 v104, v104
  v_exp_f32 v105, v105
  v_exp_f32 v106, v106
  v_smfmac_f32_32x32x32_bf16 v[128:143], v[40:43], v[96:103], v9
  s_waitcnt lgkmcnt(0)
  v_exp_f32 v107, v107
  v_exp_f32 v108, v108
  v_exp_f32 v109, v109
  v_exp_f32 v110, v110
  v_exp_f32 v111, v111
  v_exp_f32 v80, v80
  v_exp_f32 v81, v81
  v_exp_f32 v82, v82
  v_smfmac_f32_32x32x32_bf16 v[128:143], v[44:47], v[104:111], v9
  v_exp_f32 v83, v83
  v_exp_f32 v84, v84
  v_exp_f32 v85, v85
  v_mfma_f32_32x32x16_bf16 v[96:111], v[24:27], v[20:23], v[64:79]
  v_exp_f32 v86, v86
  v_exp_f32 v87, v87
  v_exp_f32 v88, v88
  v_exp_f32 v89, v89
  v_exp_f32 v90, v90
  v_smfmac_f32_32x32x32_bf16 v[112:127], v[32:35], v[80:87], v9
  s_waitcnt vmcnt(8)
  s_barrier
  s_mov_b64 exec, s[44:45]
  ds_read_b128 v[40:43], v7 offset:7168
  ds_read_b128 v[44:47], v7 offset:7680
  s_mov_b64 exec, -1
  ds_read_b128 v[24:27], v6 offset:8192
  v_exp_f32 v91, v91
  v_exp_f32 v92, v92
  v_exp_f32 v93, v93
  v_exp_f32 v94, v94
  v_exp_f32 v95, v95
  v_exp_f32 v96, v96
  v_exp_f32 v97, v97
  v_exp_f32 v98, v98
  v_smfmac_f32_32x32x32_bf16 v[112:127], v[36:39], v[88:95], v9
  v_exp_f32 v99, v99
  v_exp_f32 v100, v100
  v_exp_f32 v101, v101
  v_mfma_f32_32x32x16_bf16 v[80:95], v[28:31], v[16:19], v[48:63]
  v_exp_f32 v102, v102
  v_exp_f32 v103, v103
  v_exp_f32 v104, v104
  v_exp_f32 v105, v105
  v_exp_f32 v106, v106
  v_smfmac_f32_32x32x32_bf16 v[128:143], v[32:35], v[96:103], v9
  s_waitcnt lgkmcnt(0)
  v_exp_f32 v107, v107
  v_exp_f32 v108, v108
  v_exp_f32 v109, v109
  v_exp_f32 v110, v110
  v_exp_f32 v111, v111
  v_exp_f32 v80, v80
  v_exp_f32 v81, v81
  v_exp_f32 v82, v82
  v_smfmac_f32_32x32x32_bf16 v[128:143], v[36:39], v[104:111], v9
  v_exp_f32 v83, v83
  v_exp_f32 v84, v84
  v_exp_f32 v85, v85
  v_mfma_f32_32x32x16_bf16 v[96:111], v[28:31], v[20:23], v[64:79]
  v_exp_f32 v86, v86
  v_exp_f32 v87, v87
  v_exp_f32 v88, v88
  v_exp_f32 v89, v89
  v_exp_f32 v90, v90
  v_smfmac_f32_32x32x32_bf16 v[112:127], v[40:43], v[80:87], v9
  s_mov_b64 exec, s[44:45]
  ds_read_b128 v[32:35], v7 offset:8192
  ds_read_b128 v[36:39], v7 offset:8704
  s_mov_b64 exec, -1
  ds_read_b128 v[28:31], v6 offset:9216
  v_exp_f32 v91, v91
  v_exp_f32 v92, v92
  v_exp_f32 v93, v93
  v_exp_f32 v94, v94
  v_exp_f32 v95, v95
  v_exp_f32 v96, v96
  v_exp_f32 v97, v97
  v_exp_f32 v98, v98
  v_smfmac_f32_32x32x32_bf16 v[112:127], v[44:47], v[88:95], v9
  v_exp_f32 v99, v99
  v_exp_f32 v100, v100
  v_exp_f32 v101, v101
  v_mfma_f32_32x32x16_bf16 v[80:95], v[24:27], v[16:19], v[48:63]
  v_exp_f32 v102, v102
  v_exp_f32 v103, v103
  v_exp_f32 v104, v104
  v_exp_f32 v105, v105
  v_exp_f32 v106, v106
  v_smfmac_f32_32x32x32_bf16 v[128:143], v[40:43], v[96:103], v9
  s_waitcnt lgkmcnt(0)
  v_exp_f32 v107, v107
  v_exp_f32 v108, v108
  v_exp_f32 v109, v109
  v_exp_f32 v110, v110
  v_exp_f32 v111, v111
  v_exp_f32 v80, v80
  v_exp_f32 v81, v81
  v_exp_f32 v82, v82
  v_smfmac_f32_32x32x32_bf16 v[128:143], v[44:47], v[104:111], v9
  v_exp_f32 v83, v83
  v_exp_f32 v84, v84
  v_exp_f32 v85, v85
  v_mfma_f32_32x32x16_bf16 v[96:111], v[24:27], v[20:23], v[64:79]
  v_exp_f32 v86, v86
  v_exp_f32 v87, v87
  v_exp_f32 v88, v88
  v_exp_f32 v89, v89
  v_exp_f32 v90, v90
  v_smfmac_f32_32x32x32_bf16 v[112:127], v[32:35], v[80:87], v9
  s_add_u32 m0, s57, 0
  s_add_u32 s48, s56, 0
  buffer_load_dwordx4 v152, s[4:7], s48 offen lds
  s_add_u32 m0, s57, 1024
  s_add_u32 s48, s56, 8192
  buffer_load_dwordx4 v152, s[4:7], s48 offen lds
  s_add_u32 m0, s57, 2048
  s_add_u32 s48, s56, 16384
  buffer_load_dwordx4 v152, s[4:7], s48 offen lds
  s_add_u32 m0, s57, 3072
  s_add_u32 s48, s56, 24576
  buffer_load_dwordx4 v152, s[4:7], s48 offen lds
  s_mov_b64 exec, s[44:45]
  ds_read_b128 v[40:43], v7 offset:9216
  ds_read_b128 v[44:47], v7 offset:9728
  s_mov_b64 exec, -1
  ds_read_b128 v[24:27], v6 offset:10240
  v_exp_f32 v91, v91
  v_exp_f32 v92, v92
  v_exp_f32 v93, v93
  v_exp_f32 v94, v94
  v_exp_f32 v95, v95
  v_exp_f32 v96, v96
  v_exp_f32 v97, v97
  v_exp_f32 v98, v98
  v_smfmac_f32_32x32x32_bf16 v[112:127], v[36:39], v[88:95], v9
  v_exp_f32 v99, v99
  v_exp_f32 v100, v100
  v_exp_f32 v101, v101
  v_mfma_f32_32x32x16_bf16 v[80:95], v[28:31], v[16:19], v[48:63]
  v_exp_f32 v102, v102
  v_exp_f32 v103, v103
  v_exp_f32 v104, v104
  v_exp_f32 v105, v105
  v_exp_f32 v106, v106
  v_smfmac_f32_32x32x32_bf16 v[128:143], v[32:35], v[96:103], v9
  s_waitcnt lgkmcnt(0)
  v_exp_f32 v107, v107
  v_exp_f32 v108, v108
  v_exp_f32 v109, v109
  v_exp_f32 v110, v110
  v_exp_f32 v111, v111
  v_exp_f32 v80, v80
  v_exp_f32 v81, v81
  v_exp_f32 v82, v82
  v_smfmac_f32_32x32x32_bf16 v[128:143], v[36:39], v[104:111], v9
  v_exp_f32 v83, v83
  v_exp_f32 v84, v84
  v_exp_f32 v85, v85
  v_mfma_f32_32x32x16_bf16 v[96:111], v[28:31], v[20:23], v[64:79]
  v_exp_f32 v86, v86
  v_exp_f32 v87, v87
  v_exp_f32 v88, v88
  v_exp_f32 v89, v89
  v_exp_f32 v90, v90
  v_smfmac_f32_32x32x32_bf16 v[112:127], v[40:43], v[80:87], v9
  s_mov_b64 exec, s[44:45]
  ds_read_b128 v[32:35], v7 offset:10240
  ds_read_b128 v[36:39], v7 offset:10752
  s_mov_b64 exec, -1
  ds_read_b128 v[28:31], v6 offset:11264
  v_exp_f32 v91, v91
  v_exp_f32 v92, v92
  v_exp_f32 v93, v93
  v_exp_f32 v94, v94
  v_exp_f32 v95, v95
  v_exp_f32 v96, v96
  v_exp_f32 v97, v97
  v_exp_f32 v98, v98
  v_smfmac_f32_32x32x32_bf16 v[112:127], v[44:47], v[88:95], v9
  v_exp_f32 v99, v99
  v_exp_f32 v100, v100
  v_exp_f32 v101, v101
  v_mfma_f32_32x32x16_bf16 v[80:95], v[24:27], v[16:19], v[48:63]
  v_exp_f32 v102, v102
  v_exp_f32 v103, v103
  v_exp_f32 v104, v104
  v_exp_f32 v105, v105
  v_exp_f32 v106, v106
  v_smfmac_f32_32x32x32_bf16 v[128:143], v[40:43], v[96:103], v9
  s_waitcnt lgkmcnt(0)
  v_exp_f32 v107, v107
  v_exp_f32 v108, v108
  v_exp_f32 v109, v109
  v_exp_f32 v110, v110
  v_exp_f32 v111, v111
  v_exp_f32 v80, v80
  v_exp_f32 v81, v81
  v_exp_f32 v82, v82
  v_smfmac_f32_32x32x32_bf16 v[128:143], v[44:47], v[104:111], v9
  v_exp_f32 v83, v83
  v_exp_f32 v84, v84
  v_exp_f32 v85, v85
  v_mfma_f32_32x32x16_bf16 v[96:111], v[24:27], v[20:23], v[64:79]
  v_exp_f32 v86, v86
  v_exp_f32 v87, v87
  v_exp_f32 v88, v88
  v_exp_f32 v89, v89
  v_exp_f32 v90, v90
  v_smfmac_f32_32x32x32_bf16 v[112:127], v[32:35], v[80:87], v9
  s_mov_b64 exec, s[44:45]
  ds_read_b128 v[40:43], v7 offset:11264
  ds_read_b128 v[44:47], v7 offset:11776
  s_mov_b64 exec, -1
  ds_read_b128 v[24:27], v6 offset:12288
  v_exp_f32 v91, v91
  v_exp_f32 v92, v92
  v_exp_f32 v93, v93
  v_exp_f32 v94, v94
  v_exp_f32 v95, v95
  v_exp_f32 v96, v96
  v_exp_f32 v97, v97
  v_exp_f32 v98, v98
  v_smfmac_f32_32x32x32_bf16 v[112:127], v[36:39], v[88:95], v9
  v_exp_f32 v99, v99
  v_exp_f32 v100, v100
  v_exp_f32 v101, v101
  v_mfma_f32_32x32x16_bf16 v[80:95], v[28:31], v[16:19], v[48:63]
  v_exp_f32 v102, v102
  v_exp_f32 v103, v103
  v_exp_f32 v104, v104
  v_exp_f32 v105, v105
  v_exp_f32 v106, v106
  v_smfmac_f32_32x32x32_bf16 v[128:143], v[32:35], v[96:103], v9
  s_waitcnt lgkmcnt(0)
  v_exp_f32 v107, v107
  v_exp_f32 v108, v108
  v_exp_f32 v109, v109
  v_exp_f32 v110, v110
  v_exp_f32 v111, v111
  v_exp_f32 v80, v80
  v_exp_f32 v81, v81
  v_exp_f32 v82, v82
  v_smfmac_f32_32x32x32_bf16 v[128:143], v[36:39], v[104:111], v9
  v_exp_f32 v83, v83
  v_exp_f32 v84, v84
  v_exp_f32 v85, v85
  v_mfma_f32_32x32x16_bf16 v[96:111], v[28:31], v[20:23], v[64:79]
  v_exp_f32 v86, v86
  v_exp_f32 v87, v87
  v_exp_f32 v88, v88
  v_exp_f32 v89, v89
  v_exp_f32 v90, v90
  v_smfmac_f32_32x32x32_bf16 v[112:127], v[40:43], v[80:87], v9
  s_mov_b64 exec, s[44:45]
  ds_read_b128 v[32:35], v7 offset:12288
  ds_read_b128 v[36:39], v7 offset:12800
  s_mov_b64 exec, -1
  ds_read_b128 v[28:31], v6 offset:13312
  v_exp_f32 v91, v91
  v_exp_f32 v92, v92
  v_exp_f32 v93, v93
  v_exp_f32 v94, v94
  v_exp_f32 v95, v95
  v_exp_f32 v96, v96
  v_exp_f32 v97, v97
  v_exp_f32 v98, v98
  v_smfmac_f32_32x32x32_bf16 v[112:127], v[44:47], v[88:95], v9
  v_exp_f32 v99, v99
  v_exp_f32 v100, v100
  v_exp_f32 v101, v101
  v_mfma_f32_32x32x16_bf16 v[80:95], v[24:27], v[16:19], v[48:63]
  v_exp_f32 v102, v102
  v_exp_f32 v103, v103
  v_exp_f32 v104, v104
  v_exp_f32 v105, v105
  v_exp_f32 v106, v106
  v_smfmac_f32_32x32x32_bf16 v[128:143], v[40:43], v[96:103], v9
  s_waitcnt lgkmcnt(0)
  v_exp_f32 v107, v107
  v_exp_f32 v108, v108
  v_exp_f32 v109, v109
  v_exp_f32 v110, v110
  v_exp_f32 v111, v111
  v_exp_f32 v80, v80
  v_exp_f32 v81, v81
  v_exp_f32 v82, v82
  v_smfmac_f32_32x32x32_bf16 v[128:143], v[44:47], v[104:111], v9
  v_exp_f32 v83, v83
  v_exp_f32 v84, v84
  v_exp_f32 v85, v85
  v_mfma_f32_32x32x16_bf16 v[96:111], v[24:27], v[20:23], v[64:79]
  v_exp_f32 v86, v86
  v_exp_f32 v87, v87
  v_exp_f32 v88, v88
  v_exp_f32 v89, v89
  v_exp_f32 v90, v90
  v_smfmac_f32_32x32x32_bf16 v[112:127], v[32:35], v[80:87], v9
  s_mov_b64 exec, s[44:45]
  ds_read_b128 v[40:43], v7 offset:13312
  ds_read_b128 v[44:47], v7 offset:13824
  s_mov_b64 exec, -1
  ds_read_b128 v[24:27], v6 offset:14336
  v_exp_f32 v91, v91
  v_exp_f32 v92, v92
  v_exp_f32 v93, v93
  v_exp_f32 v94, v94
  v_exp_f32 v95, v95
  v_exp_f32 v96, v96
  v_exp_f32 v97, v97
  v_exp_f32 v98, v98
  v_smfmac_f32_32x32x32_bf16 v[112:127], v[36:39], v[88:95], v9
  v_exp_f32 v99, v99
  v_exp_f32 v100, v100
  v_exp_f32 v101, v101
  v_mfma_f32_32x32x16_bf16 v[80:95], v[28:31], v[16:19], v[48:63]
  v_exp_f32 v102, v102
  v_exp_f32 v103, v103
  v_exp_f32 v104, v104
  v_exp_f32 v105, v105
  v_exp_f32 v106, v106
  v_smfmac_f32_32x32x32_bf16 v[128:143], v[32:35], v[96:103], v9
  s_waitcnt lgkmcnt(0)
  v_exp_f32 v107, v107
  v_exp_f32 v108, v108
  v_exp_f32 v109, v109
  v_exp_f32 v110, v110
  v_exp_f32 v111, v111
  v_exp_f32 v80, v80
  v_exp_f32 v81, v81
  v_exp_f32 v82, v82
  v_smfmac_f32_32x32x32_bf16 v[128:143], v[36:39], v[104:111], v9
  v_exp_f32 v83, v83
  v_exp_f32 v84, v84
  v_exp_f32 v85, v85
  v_mfma_f32_32x32x16_bf16 v[96:111], v[28:31], v[20:23], v[64:79]
  v_exp_f32 v86, v86
  v_exp_f32 v87, v87
  v_exp_f32 v88, v88
  v_exp_f32 v89, v89
  v_exp_f32 v90, v90
  v_smfmac_f32_32x32x32_bf16 v[112:127], v[40:43], v[80:87], v9
  s_mov_b64 exec, s[44:45]
  ds_read_b128 v[32:35], v7 offset:14336
  ds_read_b128 v[36:39], v7 offset:14848
  s_mov_b64 exec, -1
  ds_read_b128 v[28:31], v6 offset:15360
  v_exp_f32 v91, v91
  v_exp_f32 v92, v92
  v_exp_f32 v93, v93
  v_exp_f32 v94, v94
  v_exp_f32 v95, v95
  v_exp_f32 v96, v96
  v_exp_f32 v97, v97
  v_exp_f32 v98, v98
  v_smfmac_f32_32x32x32_bf16 v[112:127], v[44:47], v[88:95], v9
  v_exp_f32 v99, v99
  v_exp_f32 v100, v100
  v_exp_f32 v101, v101
  v_mfma_f32_32x32x16_bf16 v[80:95], v[24:27], v[16:19], v[48:63]
  v_exp_f32 v102, v102
  v_exp_f32 v103, v103
  v_exp_f32 v104, v104
  v_exp_f32 v105, v105
  v_exp_f32 v106, v106
  v_smfmac_f32_32x32x32_bf16 v[128:143], v[40:43], v[96:103], v9
  s_waitcnt lgkmcnt(0)
  v_exp_f32 v107, v107
  v_exp_f32 v108, v108
  v_exp_f32 v109, v109
  v_exp_f32 v110, v110
  v_exp_f32 v111, v111
  v_exp_f32 v80, v80
  v_exp_f32 v81, v81
  v_exp_f32 v82, v82
  v_smfmac_f32_32x32x32_bf16 v[128:143], v[44:47], v[104:111], v9
  v_exp_f32 v83, v83
  v_exp_f32 v84, v84
  v_exp_f32 v85, v85
  v_mfma_f32_32x32x16_bf16 v[96:111], v[24:27], v[20:23], v[64:79]
  v_exp_f32 v86, v86
  v_exp_f32 v87, v87
  v_exp_f32 v88, v88
  v_exp_f32 v89, v89
  v_exp_f32 v90, v90
  v_smfmac_f32_32x32x32_bf16 v[112:127], v[32:35], v[80:87], v9
  s_waitcnt vmcnt(8)
  s_barrier
  s_add_u32 s48, s51, 32
  s_and_b32 s48, s48, 63
  s_lshl_b32 s48, s48, 11
  s_add_u32 s48, s48, s46
  s_add_u32 m0, s47, 0
  s_add_u32 s39, s48, 1024
  buffer_load_dwordx4 v5, s[12:15], s48 offen sc1 lds
  s_add_u32 m0, s47, 65536
  s_nop 0
  buffer_load_dwordx4 v5, s[12:15], s39 offen sc1 lds
  s_add_u32 s48, s51, 33
  s_and_b32 s48, s48, 63
  s_lshl_b32 s48, s48, 11
  s_add_u32 s48, s48, s46
  s_add_u32 m0, s47, 1024
  s_add_u32 s39, s48, 1024
  buffer_load_dwordx4 v5, s[12:15], s48 offen sc1 lds
  s_add_u32 m0, s47, 66560
  s_nop 0
  buffer_load_dwordx4 v5, s[12:15], s39 offen sc1 lds
  s_mov_b64 exec, s[44:45]
  ds_read_b128 v[40:43], v7 offset:15360
  ds_read_b128 v[44:47], v7 offset:15872
  s_mov_b64 exec, -1
  ds_read_b128 v[24:27], v6 offset:16384
  v_exp_f32 v91, v91
  v_exp_f32 v92, v92
  v_exp_f32 v93, v93
  v_exp_f32 v94, v94
  v_exp_f32 v95, v95
  v_exp_f32 v96, v96
  v_exp_f32 v97, v97
  v_exp_f32 v98, v98
  v_smfmac_f32_32x32x32_bf16 v[112:127], v[36:39], v[88:95], v9
  v_exp_f32 v99, v99
  v_exp_f32 v100, v100
  v_exp_f32 v101, v101
  v_mfma_f32_32x32x16_bf16 v[80:95], v[28:31], v[16:19], v[48:63]
  v_exp_f32 v102, v102
  v_exp_f32 v103, v103
  v_exp_f32 v104, v104
  v_exp_f32 v105, v105
  v_exp_f32 v106, v106
  v_smfmac_f32_32x32x32_bf16 v[128:143], v[32:35], v[96:103], v9
  s_waitcnt lgkmcnt(0)
  v_exp_f32 v107, v107
  v_exp_f32 v108, v108
  v_exp_f32 v109, v109
  v_exp_f32 v110, v110
  v_exp_f32 v111, v111
  v_exp_f32 v80, v80
  v_exp_f32 v81, v81
  v_exp_f32 v82, v82
  v_smfmac_f32_32x32x32_bf16 v[128:143], v[36:39], v[104:111], v9
  v_exp_f32 v83, v83
  v_exp_f32 v84, v84
  v_exp_f32 v85, v85
  v_mfma_f32_32x32x16_bf16 v[96:111], v[28:31], v[20:23], v[64:79]
  v_exp_f32 v86, v86
  v_exp_f32 v87, v87
  v_exp_f32 v88, v88
  v_exp_f32 v89, v89
  v_exp_f32 v90, v90
  v_smfmac_f32_32x32x32_bf16 v[112:127], v[40:43], v[80:87], v9
  s_mov_b64 exec, s[44:45]
  ds_read_b128 v[32:35], v7 offset:16384
  ds_read_b128 v[36:39], v7 offset:16896
  s_mov_b64 exec, -1
  ds_read_b128 v[28:31], v6 offset:17408
  v_exp_f32 v91, v91
  v_exp_f32 v92, v92
  v_exp_f32 v93, v93
  v_exp_f32 v94, v94
  v_exp_f32 v95, v95
  v_exp_f32 v96, v96
  v_exp_f32 v97, v97
  v_exp_f32 v98, v98
  v_smfmac_f32_32x32x32_bf16 v[112:127], v[44:47], v[88:95], v9
  v_exp_f32 v99, v99
  v_exp_f32 v100, v100
  v_exp_f32 v101, v101
  v_mfma_f32_32x32x16_bf16 v[80:95], v[24:27], v[16:19], v[48:63]
  v_exp_f32 v102, v102
  v_exp_f32 v103, v103
  v_exp_f32 v104, v104
  v_exp_f32 v105, v105
  v_exp_f32 v106, v106
  v_smfmac_f32_32x32x32_bf16 v[128:143], v[40:43], v[96:103], v9
  s_waitcnt lgkmcnt(0)
  v_exp_f32 v107, v107
  v_exp_f32 v108, v108
  v_exp_f32 v109, v109
  v_exp_f32 v110, v110
  v_exp_f32 v111, v111
  v_exp_f32 v80, v80
  v_exp_f32 v81, v81
  v_exp_f32 v82, v82
  v_smfmac_f32_32x32x32_bf16 v[128:143], v[44:47], v[104:111], v9
  v_exp_f32 v83, v83
  v_exp_f32 v84, v84
  v_exp_f32 v85, v85
  v_mfma_f32_32x32x16_bf16 v[96:111], v[24:27], v[20:23], v[64:79]
  v_exp_f32 v86, v86
  v_exp_f32 v87, v87
  v_exp_f32 v88, v88
  v_exp_f32 v89, v89
  v_exp_f32 v90, v90
  v_smfmac_f32_32x32x32_bf16 v[112:127], v[32:35], v[80:87], v9
  s_mov_b64 exec, s[44:45]
  ds_read_b128 v[40:43], v7 offset:17408
  ds_read_b128 v[44:47], v7 offset:17920
  s_mov_b64 exec, -1
  ds_read_b128 v[24:27], v6 offset:18432
  v_exp_f32 v91, v91
  v_exp_f32 v92, v92
  v_exp_f32 v93, v93
  v_exp_f32 v94, v94
  v_exp_f32 v95, v95
  v_exp_f32 v96, v96
  v_exp_f32 v97, v97
  v_exp_f32 v98, v98
  v_smfmac_f32_32x32x32_bf16 v[112:127], v[36:39], v[88:95], v9
  v_exp_f32 v99, v99
  v_exp_f32 v100, v100
  v_exp_f32 v101, v101
  v_mfma_f32_32x32x16_bf16 v[80:95], v[28:31], v[16:19], v[48:63]
  v_exp_f32 v102, v102
  v_exp_f32 v103, v103
  v_exp_f32 v104, v104
  v_exp_f32 v105, v105
  v_exp_f32 v106, v106
  v_smfmac_f32_32x32x32_bf16 v[128:143], v[32:35], v[96:103], v9
  s_waitcnt lgkmcnt(0)
  v_exp_f32 v107, v107
  v_exp_f32 v108, v108
  v_exp_f32 v109, v109
  v_exp_f32 v110, v110
  v_exp_f32 v111, v111
  v_exp_f32 v80, v80
  v_exp_f32 v81, v81
  v_exp_f32 v82, v82
  v_smfmac_f32_32x32x32_bf16 v[128:143], v[36:39], v[104:111], v9
  v_exp_f32 v83, v83
  v_exp_f32 v84, v84
  v_exp_f32 v85, v85
  v_mfma_f32_32x32x16_bf16 v[96:111], v[28:31], v[20:23], v[64:79]
  v_exp_f32 v86, v86
  v_exp_f32 v87, v87
  v_exp_f32 v88, v88
  v_exp_f32 v89, v89
  v_exp_f32 v90, v90
  v_smfmac_f32_32x32x32_bf16 v[112:127], v[40:43], v[80:87], v9
  s_mov_b64 exec, s[44:45]
  ds_read_b128 v[32:35], v7 offset:18432
  ds_read_b128 v[36:39], v7 offset:18944
  s_mov_b64 exec, -1
  ds_read_b128 v[28:31], v6 offset:19456
  v_exp_f32 v91, v91
  v_exp_f32 v92, v92
  v_exp_f32 v93, v93
  v_exp_f32 v94, v94
  v_exp_f32 v95, v95
  v_exp_f32 v96, v96
  v_exp_f32 v97, v97
  v_exp_f32 v98, v98
  v_smfmac_f32_32x32x32_bf16 v[112:127], v[44:47], v[88:95], v9
  v_exp_f32 v99, v99
  v_exp_f32 v100, v100
  v_exp_f32 v101, v101
  v_mfma_f32_32x32x16_bf16 v[80:95], v[24:27], v[16:19], v[48:63]
  v_exp_f32 v102, v102
  v_exp_f32 v103, v103
  v_exp_f32 v104, v104
  v_exp_f32 v105, v105
  v_exp_f32 v106, v106
  v_smfmac_f32_32x32x32_bf16 v[128:143], v[40:43], v[96:103], v9
  s_waitcnt lgkmcnt(0)
  v_exp_f32 v107, v107
  v_exp_f32 v108, v108
  v_exp_f32 v109, v109
  v_exp_f32 v110, v110
  v_exp_f32 v111, v111
  v_exp_f32 v80, v80
  v_exp_f32 v81, v81
  v_exp_f32 v82, v82
  v_smfmac_f32_32x32x32_bf16 v[128:143], v[44:47], v[104:111], v9
  v_exp_f32 v83, v83
  v_exp_f32 v84, v84
  v_exp_f32 v85, v85
  v_mfma_f32_32x32x16_bf16 v[96:111], v[24:27], v[20:23], v[64:79]
  v_exp_f32 v86, v86
  v_exp_f32 v87, v87
  v_exp_f32 v88, v88
  v_exp_f32 v89, v89
  v_exp_f32 v90, v90
  v_smfmac_f32_32x32x32_bf16 v[112:127], v[32:35], v[80:87], v9
  s_mov_b64 exec, s[44:45]
  ds_read_b128 v[40:43], v7 offset:19456
  ds_read_b128 v[44:47], v7 offset:19968
  s_mov_b64 exec, -1
  ds_read_b128 v[24:27], v6 offset:20480
  v_exp_f32 v91, v91
  v_exp_f32 v92, v92
  v_exp_f32 v93, v93
  v_exp_f32 v94, v94
  v_exp_f32 v95, v95
  v_exp_f32 v96, v96
  v_exp_f32 v97, v97
  v_exp_f32 v98, v98
  v_smfmac_f32_32x32x32_bf16 v[112:127], v[36:39], v[88:95], v9
  v_exp_f32 v99, v99
  v_exp_f32 v100, v100
  v_exp_f32 v101, v101
  v_mfma_f32_32x32x16_bf16 v[80:95], v[28:31], v[16:19], v[48:63]
  v_exp_f32 v102, v102
  v_exp_f32 v103, v103
  v_exp_f32 v104, v104
  v_exp_f32 v105, v105
  v_exp_f32 v106, v106
  v_smfmac_f32_32x32x32_bf16 v[128:143], v[32:35], v[96:103], v9
  s_waitcnt lgkmcnt(0)
  v_exp_f32 v107, v107
  v_exp_f32 v108, v108
  v_exp_f32 v109, v109
  v_exp_f32 v110, v110
  v_exp_f32 v111, v111
  v_exp_f32 v80, v80
  v_exp_f32 v81, v81
  v_exp_f32 v82, v82
  v_smfmac_f32_32x32x32_bf16 v[128:143], v[36:39], v[104:111], v9
  v_exp_f32 v83, v83
  v_exp_f32 v84, v84
  v_exp_f32 v85, v85
  v_mfma_f32_32x32x16_bf16 v[96:111], v[28:31], v[20:23], v[64:79]
  v_exp_f32 v86, v86
  v_exp_f32 v87, v87
  v_exp_f32 v88, v88
  v_exp_f32 v89, v89
  v_exp_f32 v90, v90
  v_smfmac_f32_32x32x32_bf16 v[112:127], v[40:43], v[80:87], v9
  s_mov_b64 exec, s[44:45]
  ds_read_b128 v[32:35], v7 offset:20480
  ds_read_b128 v[36:39], v7 offset:20992
  s_mov_b64 exec, -1
  ds_read_b128 v[28:31], v6 offset:21504
  v_exp_f32 v91, v91
  v_exp_f32 v92, v92
  v_exp_f32 v93, v93
  v_exp_f32 v94, v94
  v_exp_f32 v95, v95
  v_exp_f32 v96, v96
  v_exp_f32 v97, v97
  v_exp_f32 v98, v98
  v_smfmac_f32_32x32x32_bf16 v[112:127], v[44:47], v[88:95], v9
  v_exp_f32 v99, v99
  v_exp_f32 v100, v100
  v_exp_f32 v101, v101
  v_mfma_f32_32x32x16_bf16 v[80:95], v[24:27], v[16:19], v[48:63]
  v_exp_f32 v102, v102
  v_exp_f32 v103, v103
  v_exp_f32 v104, v104
  v_exp_f32 v105, v105
  v_exp_f32 v106, v106
  v_smfmac_f32_32x32x32_bf16 v[128:143], v[40:43], v[96:103], v9
  s_waitcnt lgkmcnt(0)
  v_exp_f32 v107, v107
  v_exp_f32 v108, v108
  v_exp_f32 v109, v109
  v_exp_f32 v110, v110
  v_exp_f32 v111, v111
  v_exp_f32 v80, v80
  v_exp_f32 v81, v81
  v_exp_f32 v82, v82
  v_smfmac_f32_32x32x32_bf16 v[128:143], v[44:47], v[104:111], v9
  v_exp_f32 v83, v83
  v_exp_f32 v84, v84
  v_exp_f32 v85, v85
  v_mfma_f32_32x32x16_bf16 v[96:111], v[24:27], v[20:23], v[64:79]
  v_exp_f32 v86, v86
  v_exp_f32 v87, v87
  v_exp_f32 v88, v88
  v_exp_f32 v89, v89
  v_exp_f32 v90, v90
  v_smfmac_f32_32x32x32_bf16 v[112:127], v[32:35], v[80:87], v9
  s_mov_b64 exec, s[44:45]
  ds_read_b128 v[40:43], v7 offset:21504
  ds_read_b128 v[44:47], v7 offset:22016
  s_mov_b64 exec, -1
  ds_read_b128 v[24:27], v6 offset:22528
  v_exp_f32 v91, v91
  v_exp_f32 v92, v92
  v_exp_f32 v93, v93
  v_exp_f32 v94, v94
  v_exp_f32 v95, v95
  v_exp_f32 v96, v96
  v_exp_f32 v97, v97
  v_exp_f32 v98, v98
  v_smfmac_f32_32x32x32_bf16 v[112:127], v[36:39], v[88:95], v9
  v_exp_f32 v99, v99
  v_exp_f32 v100, v100
  v_exp_f32 v101, v101
  v_mfma_f32_32x32x16_bf16 v[80:95], v[28:31], v[16:19], v[48:63]
  v_exp_f32 v102, v102
  v_exp_f32 v103, v103
  v_exp_f32 v104, v104
  v_exp_f32 v105, v105
  v_exp_f32 v106, v106
  v_smfmac_f32_32x32x32_bf16 v[128:143], v[32:35], v[96:103], v9
  s_waitcnt lgkmcnt(0)
  v_exp_f32 v107, v107
  v_exp_f32 v108, v108
  v_exp_f32 v109, v109
  v_exp_f32 v110, v110
  v_exp_f32 v111, v111
  v_exp_f32 v80, v80
  v_exp_f32 v81, v81
  v_exp_f32 v82, v82
  v_smfmac_f32_32x32x32_bf16 v[128:143], v[36:39], v[104:111], v9
  v_exp_f32 v83, v83
  v_exp_f32 v84, v84
  v_exp_f32 v85, v85
  v_mfma_f32_32x32x16_bf16 v[96:111], v[28:31], v[20:23], v[64:79]
  v_exp_f32 v86, v86
  v_exp_f32 v87, v87
  v_exp_f32 v88, v88
  v_exp_f32 v89, v89
  v_exp_f32 v90, v90
  v_smfmac_f32_32x32x32_bf16 v[112:127], v[40:43], v[80:87], v9
  s_mov_b64 exec, s[44:45]
  ds_read_b128 v[32:35], v7 offset:22528
  ds_read_b128 v[36:39], v7 offset:23040
  s_mov_b64 exec, -1
  ds_read_b128 v[28:31], v6 offset:23552
  v_exp_f32 v91, v91
  v_exp_f32 v92, v92
  v_exp_f32 v93, v93
  v_exp_f32 v94, v94
  v_exp_f32 v95, v95
  v_exp_f32 v96, v96
  v_exp_f32 v97, v97
  v_exp_f32 v98, v98
  v_smfmac_f32_32x32x32_bf16 v[112:127], v[44:47], v[88:95], v9
  v_exp_f32 v99, v99
  v_exp_f32 v100, v100
  v_exp_f32 v101, v101
  v_mfma_f32_32x32x16_bf16 v[80:95], v[24:27], v[16:19], v[48:63]
  v_exp_f32 v102, v102
  v_exp_f32 v103, v103
  v_exp_f32 v104, v104
  v_exp_f32 v105, v105
  v_exp_f32 v106, v106
  v_smfmac_f32_32x32x32_bf16 v[128:143], v[40:43], v[96:103], v9
  s_waitcnt lgkmcnt(0)
  v_exp_f32 v107, v107
  v_exp_f32 v108, v108
  v_exp_f32 v109, v109
  v_exp_f32 v110, v110
  v_exp_f32 v111, v111
  v_exp_f32 v80, v80
  v_exp_f32 v81, v81
  v_exp_f32 v82, v82
  v_smfmac_f32_32x32x32_bf16 v[128:143], v[44:47], v[104:111], v9
  v_exp_f32 v83, v83
  v_exp_f32 v84, v84
  v_exp_f32 v85, v85
  v_mfma_f32_32x32x16_bf16 v[96:111], v[24:27], v[20:23], v[64:79]
  v_exp_f32 v86, v86
  v_exp_f32 v87, v87
  v_exp_f32 v88, v88
  v_exp_f32 v89, v89
  v_exp_f32 v90, v90
  v_smfmac_f32_32x32x32_bf16 v[112:127], v[32:35], v[80:87], v9
  s_waitcnt vmcnt(8)
  s_barrier
  s_add_u32 s48, s51, 40
  s_and_b32 s48, s48, 63
  s_lshl_b32 s48, s48, 11
  s_add_u32 s48, s48, s46
  s_add_u32 m0, s47, 8192
  s_add_u32 s39, s48, 1024
  buffer_load_dwordx4 v5, s[12:15], s48 offen sc1 lds
  s_add_u32 m0, s47, 73728
  s_nop 0
  buffer_load_dwordx4 v5, s[12:15], s39 offen sc1 lds
  s_add_u32 s48, s51, 41
  s_and_b32 s48, s48, 63
  s_lshl_b32 s48, s48, 11
  s_add_u32 s48, s48, s46
  s_add_u32 m0, s47, 9216
  s_add_u32 s39, s48, 1024
  buffer_load_dwordx4 v5, s[12:15], s48 offen sc1 lds
  s_add_u32 m0, s47, 74752
  s_nop 0
  buffer_load_dwordx4 v5, s[12:15], s39 offen sc1 lds
  s_mov_b64 exec, s[44:45]
  ds_read_b128 v[40:43], v7 offset:23552
  ds_read_b128 v[44:47], v7 offset:24064
  s_mov_b64 exec, -1
  ds_read_b128 v[24:27], v6 offset:24576
  v_exp_f32 v91, v91
  v_exp_f32 v92, v92
  v_exp_f32 v93, v93
  v_exp_f32 v94, v94
  v_exp_f32 v95, v95
  v_exp_f32 v96, v96
  v_exp_f32 v97, v97
  v_exp_f32 v98, v98
  v_smfmac_f32_32x32x32_bf16 v[112:127], v[36:39], v[88:95], v9
  v_exp_f32 v99, v99
  v_exp_f32 v100, v100
  v_exp_f32 v101, v101
  v_mfma_f32_32x32x16_bf16 v[80:95], v[28:31], v[16:19], v[48:63]
  v_exp_f32 v102, v102
  v_exp_f32 v103, v103
  v_exp_f32 v104, v104
  v_exp_f32 v105, v105
  v_exp_f32 v106, v106
  v_smfmac_f32_32x32x32_bf16 v[128:143], v[32:35], v[96:103], v9
  s_waitcnt lgkmcnt(0)
  v_exp_f32 v107, v107
  v_exp_f32 v108, v108
  v_exp_f32 v109, v109
  v_exp_f32 v110, v110
  v_exp_f32 v111, v111
  v_exp_f32 v80, v80
  v_exp_f32 v81, v81
  v_exp_f32 v82, v82
  v_smfmac_f32_32x32x32_bf16 v[128:143], v[36:39], v[104:111], v9
  v_exp_f32 v83, v83
  v_exp_f32 v84, v84
  v_exp_f32 v85, v85
  v_mfma_f32_32x32x16_bf16 v[96:111], v[28:31], v[20:23], v[64:79]
  v_exp_f32 v86, v86
  v_exp_f32 v87, v87
  v_exp_f32 v88, v88
  v_exp_f32 v89, v89
  v_exp_f32 v90, v90
  v_smfmac_f32_32x32x32_bf16 v[112:127], v[40:43], v[80:87], v9
  s_mov_b64 exec, s[44:45]
  ds_read_b128 v[32:35], v7 offset:24576
  ds_read_b128 v[36:39], v7 offset:25088
  s_mov_b64 exec, -1
  ds_read_b128 v[28:31], v6 offset:25600
  v_exp_f32 v91, v91
  v_exp_f32 v92, v92
  v_exp_f32 v93, v93
  v_exp_f32 v94, v94
  v_exp_f32 v95, v95
  v_exp_f32 v96, v96
  v_exp_f32 v97, v97
  v_exp_f32 v98, v98
  v_smfmac_f32_32x32x32_bf16 v[112:127], v[44:47], v[88:95], v9
  v_exp_f32 v99, v99
  v_exp_f32 v100, v100
  v_exp_f32 v101, v101
  v_mfma_f32_32x32x16_bf16 v[80:95], v[24:27], v[16:19], v[48:63]
  v_exp_f32 v102, v102
  v_exp_f32 v103, v103
  v_exp_f32 v104, v104
  v_exp_f32 v105, v105
  v_exp_f32 v106, v106
  v_smfmac_f32_32x32x32_bf16 v[128:143], v[40:43], v[96:103], v9
  s_waitcnt lgkmcnt(0)
  v_exp_f32 v107, v107
  v_exp_f32 v108, v108
  v_exp_f32 v109, v109
  v_exp_f32 v110, v110
  v_exp_f32 v111, v111
  v_exp_f32 v80, v80
  v_exp_f32 v81, v81
  v_exp_f32 v82, v82
  v_smfmac_f32_32x32x32_bf16 v[128:143], v[44:47], v[104:111], v9
  v_exp_f32 v83, v83
  v_exp_f32 v84, v84
  v_exp_f32 v85, v85
  v_mfma_f32_32x32x16_bf16 v[96:111], v[24:27], v[20:23], v[64:79]
  v_exp_f32 v86, v86
  v_exp_f32 v87, v87
  v_exp_f32 v88, v88
  v_exp_f32 v89, v89
  v_exp_f32 v90, v90
  v_smfmac_f32_32x32x32_bf16 v[112:127], v[32:35], v[80:87], v9
  s_mov_b64 exec, s[44:45]
  ds_read_b128 v[40:43], v7 offset:25600
  ds_read_b128 v[44:47], v7 offset:26112
  s_mov_b64 exec, -1
  ds_read_b128 v[24:27], v6 offset:26624
  v_exp_f32 v91, v91
  v_exp_f32 v92, v92
  v_exp_f32 v93, v93
  v_exp_f32 v94, v94
  v_exp_f32 v95, v95
  v_exp_f32 v96, v96
  v_exp_f32 v97, v97
  v_exp_f32 v98, v98
  v_smfmac_f32_32x32x32_bf16 v[112:127], v[36:39], v[88:95], v9
  v_exp_f32 v99, v99
  v_exp_f32 v100, v100
  v_exp_f32 v101, v101
  v_mfma_f32_32x32x16_bf16 v[80:95], v[28:31], v[16:19], v[48:63]
  v_exp_f32 v102, v102
  v_exp_f32 v103, v103
  v_exp_f32 v104, v104
  v_exp_f32 v105, v105
  v_exp_f32 v106, v106
  v_smfmac_f32_32x32x32_bf16 v[128:143], v[32:35], v[96:103], v9
  s_waitcnt lgkmcnt(0)
  v_exp_f32 v107, v107
  v_exp_f32 v108, v108
  v_exp_f32 v109, v109
  v_exp_f32 v110, v110
  v_exp_f32 v111, v111
  v_exp_f32 v80, v80
  v_exp_f32 v81, v81
  v_exp_f32 v82, v82
  v_smfmac_f32_32x32x32_bf16 v[128:143], v[36:39], v[104:111], v9
  v_exp_f32 v83, v83
  v_exp_f32 v84, v84
  v_exp_f32 v85, v85
  v_mfma_f32_32x32x16_bf16 v[96:111], v[28:31], v[20:23], v[64:79]
  v_exp_f32 v86, v86
  v_exp_f32 v87, v87
  v_exp_f32 v88, v88
  v_exp_f32 v89, v89
  v_exp_f32 v90, v90
  v_smfmac_f32_32x32x32_bf16 v[112:127], v[40:43], v[80:87], v9
  s_mov_b64 exec, s[44:45]
  ds_read_b128 v[32:35], v7 offset:26624
  ds_read_b128 v[36:39], v7 offset:27136
  s_mov_b64 exec, -1
  ds_read_b128 v[28:31], v6 offset:27648
  v_exp_f32 v91, v91
  v_exp_f32 v92, v92
  v_exp_f32 v93, v93
  v_exp_f32 v94, v94
  v_exp_f32 v95, v95
  v_exp_f32 v96, v96
  v_exp_f32 v97, v97
  v_exp_f32 v98, v98
  v_smfmac_f32_32x32x32_bf16 v[112:127], v[44:47], v[88:95], v9
  v_exp_f32 v99, v99
  v_exp_f32 v100, v100
  v_exp_f32 v101, v101
  v_mfma_f32_32x32x16_bf16 v[80:95], v[24:27], v[16:19], v[48:63]
  v_exp_f32 v102, v102
  v_exp_f32 v103, v103
  v_exp_f32 v104, v104
  v_exp_f32 v105, v105
  v_exp_f32 v106, v106
  v_smfmac_f32_32x32x32_bf16 v[128:143], v[40:43], v[96:103], v9
  s_waitcnt lgkmcnt(0)
  v_exp_f32 v107, v107
  v_exp_f32 v108, v108
  v_exp_f32 v109, v109
  v_exp_f32 v110, v110
  v_exp_f32 v111, v111
  v_exp_f32 v80, v80
  v_exp_f32 v81, v81
  v_exp_f32 v82, v82
  v_smfmac_f32_32x32x32_bf16 v[128:143], v[44:47], v[104:111], v9
  v_exp_f32 v83, v83
  v_exp_f32 v84, v84
  v_exp_f32 v85, v85
  v_mfma_f32_32x32x16_bf16 v[96:111], v[24:27], v[20:23], v[64:79]
  v_exp_f32 v86, v86
  v_exp_f32 v87, v87
  v_exp_f32 v88, v88
  v_exp_f32 v89, v89
  v_exp_f32 v90, v90
  v_smfmac_f32_32x32x32_bf16 v[112:127], v[32:35], v[80:87], v9
  s_mov_b64 exec, s[44:45]
  ds_read_b128 v[40:43], v7 offset:27648
  ds_read_b128 v[44:47], v7 offset:28160
  s_mov_b64 exec, -1
  ds_read_b128 v[24:27], v6 offset:28672
  v_exp_f32 v91, v91
  v_exp_f32 v92, v92
  v_exp_f32 v93, v93
  v_exp_f32 v94, v94
  v_exp_f32 v95, v95
  v_exp_f32 v96, v96
  v_exp_f32 v97, v97
  v_exp_f32 v98, v98
  v_smfmac_f32_32x32x32_bf16 v[112:127], v[36:39], v[88:95], v9
  v_exp_f32 v99, v99
  v_exp_f32 v100, v100
  v_exp_f32 v101, v101
  v_mfma_f32_32x32x16_bf16 v[80:95], v[28:31], v[16:19], v[48:63]
  v_exp_f32 v102, v102
  v_exp_f32 v103, v103
  v_exp_f32 v104, v104
  v_exp_f32 v105, v105
  v_exp_f32 v106, v106
  v_smfmac_f32_32x32x32_bf16 v[128:143], v[32:35], v[96:103], v9
  s_waitcnt lgkmcnt(0)
  v_exp_f32 v107, v107
  v_exp_f32 v108, v108
  v_exp_f32 v109, v109
  v_exp_f32 v110, v110
  v_exp_f32 v111, v111
  v_exp_f32 v80, v80
  v_exp_f32 v81, v81
  v_exp_f32 v82, v82
  v_smfmac_f32_32x32x32_bf16 v[128:143], v[36:39], v[104:111], v9
  v_exp_f32 v83, v83
  v_exp_f32 v84, v84
  v_exp_f32 v85, v85
  v_mfma_f32_32x32x16_bf16 v[96:111], v[28:31], v[20:23], v[64:79]
  v_exp_f32 v86, v86
  v_exp_f32 v87, v87
  v_exp_f32 v88, v88
  v_exp_f32 v89, v89
  v_exp_f32 v90, v90
  v_smfmac_f32_32x32x32_bf16 v[112:127], v[40:43], v[80:87], v9
  s_mov_b64 exec, s[44:45]
  ds_read_b128 v[32:35], v7 offset:28672
  ds_read_b128 v[36:39], v7 offset:29184
  s_mov_b64 exec, -1
  ds_read_b128 v[28:31], v6 offset:29696
  v_exp_f32 v91, v91
  v_exp_f32 v92, v92
  v_exp_f32 v93, v93
  v_exp_f32 v94, v94
  v_exp_f32 v95, v95
  v_exp_f32 v96, v96
  v_exp_f32 v97, v97
  v_exp_f32 v98, v98
  v_smfmac_f32_32x32x32_bf16 v[112:127], v[44:47], v[88:95], v9
  v_exp_f32 v99, v99
  v_exp_f32 v100, v100
  v_exp_f32 v101, v101
  v_mfma_f32_32x32x16_bf16 v[80:95], v[24:27], v[16:19], v[48:63]
  v_exp_f32 v102, v102
  v_exp_f32 v103, v103
  v_exp_f32 v104, v104
  v_exp_f32 v105, v105
  v_exp_f32 v106, v106
  v_smfmac_f32_32x32x32_bf16 v[128:143], v[40:43], v[96:103], v9
  s_waitcnt lgkmcnt(0)
  v_exp_f32 v107, v107
  v_exp_f32 v108, v108
  v_exp_f32 v109, v109
  v_exp_f32 v110, v110
  v_exp_f32 v111, v111
  v_exp_f32 v80, v80
  v_exp_f32 v81, v81
  v_exp_f32 v82, v82
  v_smfmac_f32_32x32x32_bf16 v[128:143], v[44:47], v[104:111], v9
  v_exp_f32 v83, v83
  v_exp_f32 v84, v84
  v_exp_f32 v85, v85
  v_mfma_f32_32x32x16_bf16 v[96:111], v[24:27], v[20:23], v[64:79]
  v_exp_f32 v86, v86
  v_exp_f32 v87, v87
  v_exp_f32 v88, v88
  v_exp_f32 v89, v89
  v_exp_f32 v90, v90
  v_smfmac_f32_32x32x32_bf16 v[112:127], v[32:35], v[80:87], v9
  s_mov_b64 exec, s[44:45]
  ds_read_b128 v[40:43], v7 offset:29696
  ds_read_b128 v[44:47], v7 offset:30208
  s_mov_b64 exec, -1
  ds_read_b128 v[24:27], v6 offset:30720
  v_exp_f32 v91, v91
  v_exp_f32 v92, v92
  v_exp_f32 v93, v93
  v_exp_f32 v94, v94
  v_exp_f32 v95, v95
  v_exp_f32 v96, v96
  v_exp_f32 v97, v97
  v_exp_f32 v98, v98
  v_smfmac_f32_32x32x32_bf16 v[112:127], v[36:39], v[88:95], v9
  v_exp_f32 v99, v99
  v_exp_f32 v100, v100
  v_exp_f32 v101, v101
  v_mfma_f32_32x32x16_bf16 v[80:95], v[28:31], v[16:19], v[48:63]
  v_exp_f32 v102, v102
  v_exp_f32 v103, v103
  v_exp_f32 v104, v104
  v_exp_f32 v105, v105
  v_exp_f32 v106, v106
  v_smfmac_f32_32x32x32_bf16 v[128:143], v[32:35], v[96:103], v9
  s_waitcnt lgkmcnt(0)
  v_exp_f32 v107, v107
  v_exp_f32 v108, v108
  v_exp_f32 v109, v109
  v_exp_f32 v110, v110
  v_exp_f32 v111, v111
  v_exp_f32 v80, v80
  v_exp_f32 v81, v81
  v_exp_f32 v82, v82
  v_smfmac_f32_32x32x32_bf16 v[128:143], v[36:39], v[104:111], v9
  v_exp_f32 v83, v83
  v_exp_f32 v84, v84
  v_exp_f32 v85, v85
  v_mfma_f32_32x32x16_bf16 v[96:111], v[28:31], v[20:23], v[64:79]
  v_exp_f32 v86, v86
  v_exp_f32 v87, v87
  v_exp_f32 v88, v88
  v_exp_f32 v89, v89
  v_exp_f32 v90, v90
  v_smfmac_f32_32x32x32_bf16 v[112:127], v[40:43], v[80:87], v9
  s_mov_b64 exec, s[44:45]
  ds_read_b128 v[32:35], v7 offset:30720
  ds_read_b128 v[36:39], v7 offset:31232
  s_mov_b64 exec, -1
  ds_read_b128 v[28:31], v6 offset:31744
  v_exp_f32 v91, v91
  v_exp_f32 v92, v92
  v_exp_f32 v93, v93
  v_exp_f32 v94, v94
  v_exp_f32 v95, v95
  v_exp_f32 v96, v96
  v_exp_f32 v97, v97
  v_exp_f32 v98, v98
  v_smfmac_f32_32x32x32_bf16 v[112:127], v[44:47], v[88:95], v9
  v_exp_f32 v99, v99
  v_exp_f32 v100, v100
  v_exp_f32 v101, v101
  v_mfma_f32_32x32x16_bf16 v[80:95], v[24:27], v[16:19], v[48:63]
  v_exp_f32 v102, v102
  v_exp_f32 v103, v103
  v_exp_f32 v104, v104
  v_exp_f32 v105, v105
  v_exp_f32 v106, v106
  v_smfmac_f32_32x32x32_bf16 v[128:143], v[40:43], v[96:103], v9
  s_waitcnt lgkmcnt(0)
  v_exp_f32 v107, v107
  v_exp_f32 v108, v108
  v_exp_f32 v109, v109
  v_exp_f32 v110, v110
  v_exp_f32 v111, v111
  v_exp_f32 v80, v80
  v_exp_f32 v81, v81
  v_exp_f32 v82, v82
  v_smfmac_f32_32x32x32_bf16 v[128:143], v[44:47], v[104:111], v9
  v_exp_f32 v83, v83
  v_exp_f32 v84, v84
  v_exp_f32 v85, v85
  v_mfma_f32_32x32x16_bf16 v[96:111], v[24:27], v[20:23], v[64:79]
  v_exp_f32 v86, v86
  v_exp_f32 v87, v87
  v_exp_f32 v88, v88
  v_exp_f32 v89, v89
  v_exp_f32 v90, v90
  v_smfmac_f32_32x32x32_bf16 v[112:127], v[32:35], v[80:87], v9
  s_waitcnt vmcnt(4)
  s_barrier
  s_add_u32 s48, s51, 48
  s_and_b32 s48, s48, 63
  s_lshl_b32 s48, s48, 11
  s_add_u32 s48, s48, s46
  s_add_u32 m0, s47, 16384
  s_add_u32 s39, s48, 1024
  buffer_load_dwordx4 v5, s[12:15], s48 offen sc1 lds
  s_add_u32 m0, s47, 81920
  s_nop 0
  buffer_load_dwordx4 v5, s[12:15], s39 offen sc1 lds
  s_add_u32 s48, s51, 49
  s_and_b32 s48, s48, 63
  s_lshl_b32 s48, s48, 11
  s_add_u32 s48, s48, s46
  s_add_u32 m0, s47, 17408
  s_add_u32 s39, s48, 1024
  buffer_load_dwordx4 v5, s[12:15], s48 offen sc1 lds
  s_add_u32 m0, s47, 82944
  s_nop 0
  buffer_load_dwordx4 v5, s[12:15], s39 offen sc1 lds
  s_mov_b64 exec, s[44:45]
  ds_read_b128 v[40:43], v7 offset:31744
  ds_read_b128 v[44:47], v7 offset:32256
  s_mov_b64 exec, -1
  ds_read_b128 v[24:27], v6 offset:0
  v_exp_f32 v91, v91
  v_exp_f32 v92, v92
  v_exp_f32 v93, v93
  v_exp_f32 v94, v94
  v_exp_f32 v95, v95
  v_exp_f32 v96, v96
  v_exp_f32 v97, v97
  v_exp_f32 v98, v98
  v_smfmac_f32_32x32x32_bf16 v[112:127], v[36:39], v[88:95], v9
  v_exp_f32 v99, v99
  v_exp_f32 v100, v100
  v_exp_f32 v101, v101
  v_mfma_f32_32x32x16_bf16 v[80:95], v[28:31], v[16:19], v[48:63]
  v_exp_f32 v102, v102
  v_exp_f32 v103, v103
  v_exp_f32 v104, v104
  v_exp_f32 v105, v105
  v_exp_f32 v106, v106
  v_smfmac_f32_32x32x32_bf16 v[128:143], v[32:35], v[96:103], v9
  s_waitcnt lgkmcnt(0)
  v_exp_f32 v107, v107
  v_exp_f32 v108, v108
  v_exp_f32 v109, v109
  v_exp_f32 v110, v110
  v_exp_f32 v111, v111
  v_exp_f32 v80, v80
  v_exp_f32 v81, v81
  v_exp_f32 v82, v82
  v_smfmac_f32_32x32x32_bf16 v[128:143], v[36:39], v[104:111], v9
  v_exp_f32 v83, v83
  v_exp_f32 v84, v84
  v_exp_f32 v85, v85
  v_mfma_f32_32x32x16_bf16 v[96:111], v[28:31], v[20:23], v[64:79]
  v_exp_f32 v86, v86
  v_exp_f32 v87, v87
  v_exp_f32 v88, v88
  v_exp_f32 v89, v89
  v_exp_f32 v90, v90
  v_smfmac_f32_32x32x32_bf16 v[112:127], v[40:43], v[80:87], v9
  s_mov_b64 exec, s[44:45]
  ds_read_b128 v[32:35], v7 offset:0
  ds_read_b128 v[36:39], v7 offset:512
  s_mov_b64 exec, -1
  ds_read_b128 v[28:31], v6 offset:1024
  v_exp_f32 v91, v91
  v_exp_f32 v92, v92
  v_exp_f32 v93, v93
  v_exp_f32 v94, v94
  v_exp_f32 v95, v95
  v_exp_f32 v96, v96
  v_exp_f32 v97, v97
  v_exp_f32 v98, v98
  v_smfmac_f32_32x32x32_bf16 v[112:127], v[44:47], v[88:95], v9
  v_exp_f32 v99, v99
  v_exp_f32 v100, v100
  v_exp_f32 v101, v101
  v_mfma_f32_32x32x16_bf16 v[80:95], v[24:27], v[16:19], v[48:63]
  v_exp_f32 v102, v102
  v_exp_f32 v103, v103
  v_exp_f32 v104, v104
  v_exp_f32 v105, v105
  v_exp_f32 v106, v106
  v_smfmac_f32_32x32x32_bf16 v[128:143], v[40:43], v[96:103], v9
  s_waitcnt lgkmcnt(0)
  v_exp_f32 v107, v107
  v_exp_f32 v108, v108
  v_exp_f32 v109, v109
  v_exp_f32 v110, v110
  v_exp_f32 v111, v111
  v_exp_f32 v80, v80
  v_exp_f32 v81, v81
  v_exp_f32 v82, v82
  v_smfmac_f32_32x32x32_bf16 v[128:143], v[44:47], v[104:111], v9
  v_exp_f32 v83, v83
  v_exp_f32 v84, v84
  v_exp_f32 v85, v85
  v_mfma_f32_32x32x16_bf16 v[96:111], v[24:27], v[20:23], v[64:79]
  v_exp_f32 v86, v86
  v_exp_f32 v87, v87
  v_exp_f32 v88, v88
  v_exp_f32 v89, v89
  v_exp_f32 v90, v90
  v_smfmac_f32_32x32x32_bf16 v[112:127], v[32:35], v[80:87], v9
  s_mov_b64 exec, s[44:45]
  ds_read_b128 v[40:43], v7 offset:1024
  ds_read_b128 v[44:47], v7 offset:1536
  s_mov_b64 exec, -1
  ds_read_b128 v[24:27], v6 offset:2048
  v_exp_f32 v91, v91
  v_exp_f32 v92, v92
  v_exp_f32 v93, v93
  v_exp_f32 v94, v94
  v_exp_f32 v95, v95
  v_exp_f32 v96, v96
  v_exp_f32 v97, v97
  v_exp_f32 v98, v98
  v_smfmac_f32_32x32x32_bf16 v[112:127], v[36:39], v[88:95], v9
  v_exp_f32 v99, v99
  v_exp_f32 v100, v100
  v_exp_f32 v101, v101
  v_mfma_f32_32x32x16_bf16 v[80:95], v[28:31], v[16:19], v[48:63]
  v_exp_f32 v102, v102
  v_exp_f32 v103, v103
  v_exp_f32 v104, v104
  v_exp_f32 v105, v105
  v_exp_f32 v106, v106
  v_smfmac_f32_32x32x32_bf16 v[128:143], v[32:35], v[96:103], v9
  s_waitcnt lgkmcnt(0)
  v_exp_f32 v107, v107
  v_exp_f32 v108, v108
  v_exp_f32 v109, v109
  v_exp_f32 v110, v110
  v_exp_f32 v111, v111
  v_exp_f32 v80, v80
  v_exp_f32 v81, v81
  v_exp_f32 v82, v82
  v_smfmac_f32_32x32x32_bf16 v[128:143], v[36:39], v[104:111], v9
  v_exp_f32 v83, v83
  v_exp_f32 v84, v84
  v_exp_f32 v85, v85
  v_mfma_f32_32x32x16_bf16 v[96:111], v[28:31], v[20:23], v[64:79]
  v_exp_f32 v86, v86
  v_exp_f32 v87, v87
  v_exp_f32 v88, v88
  v_exp_f32 v89, v89
  v_exp_f32 v90, v90
  v_smfmac_f32_32x32x32_bf16 v[112:127], v[40:43], v[80:87], v9
  s_mov_b64 exec, s[44:45]
  ds_read_b128 v[32:35], v7 offset:2048
  ds_read_b128 v[36:39], v7 offset:2560
  s_mov_b64 exec, -1
  ds_read_b128 v[28:31], v6 offset:3072
  v_exp_f32 v91, v91
  v_exp_f32 v92, v92
  v_exp_f32 v93, v93
  v_exp_f32 v94, v94
  v_exp_f32 v95, v95
  v_exp_f32 v96, v96
  v_exp_f32 v97, v97
  v_exp_f32 v98, v98
  v_smfmac_f32_32x32x32_bf16 v[112:127], v[44:47], v[88:95], v9
  v_exp_f32 v99, v99
  v_exp_f32 v100, v100
  v_exp_f32 v101, v101
  v_mfma_f32_32x32x16_bf16 v[80:95], v[24:27], v[16:19], v[48:63]
  v_exp_f32 v102, v102
  v_exp_f32 v103, v103
  v_exp_f32 v104, v104
  v_exp_f32 v105, v105
  v_exp_f32 v106, v106
  v_smfmac_f32_32x32x32_bf16 v[128:143], v[40:43], v[96:103], v9
  s_waitcnt lgkmcnt(0)
  v_exp_f32 v107, v107
  v_exp_f32 v108, v108
  v_exp_f32 v109, v109
  v_exp_f32 v110, v110
  v_exp_f32 v111, v111
  v_exp_f32 v80, v80
  v_exp_f32 v81, v81
  v_exp_f32 v82, v82
  v_smfmac_f32_32x32x32_bf16 v[128:143], v[44:47], v[104:111], v9
  v_exp_f32 v83, v83
  v_exp_f32 v84, v84
  v_exp_f32 v85, v85
  v_mfma_f32_32x32x16_bf16 v[96:111], v[24:27], v[20:23], v[64:79]
  v_exp_f32 v86, v86
  v_exp_f32 v87, v87
  v_exp_f32 v88, v88
  v_exp_f32 v89, v89
  v_exp_f32 v90, v90
  v_smfmac_f32_32x32x32_bf16 v[112:127], v[32:35], v[80:87], v9
  s_mov_b64 exec, s[44:45]
  ds_read_b128 v[40:43], v7 offset:3072
  ds_read_b128 v[44:47], v7 offset:3584
  s_mov_b64 exec, -1
  ds_read_b128 v[24:27], v6 offset:4096
  v_exp_f32 v91, v91
  v_exp_f32 v92, v92
  v_exp_f32 v93, v93
  v_exp_f32 v94, v94
  v_exp_f32 v95, v95
  v_exp_f32 v96, v96
  v_exp_f32 v97, v97
  v_exp_f32 v98, v98
  v_smfmac_f32_32x32x32_bf16 v[112:127], v[36:39], v[88:95], v9
  v_exp_f32 v99, v99
  v_exp_f32 v100, v100
  v_exp_f32 v101, v101
  v_mfma_f32_32x32x16_bf16 v[80:95], v[28:31], v[16:19], v[48:63]
  v_exp_f32 v102, v102
  v_exp_f32 v103, v103
  v_exp_f32 v104, v104
  v_exp_f32 v105, v105
  v_exp_f32 v106, v106
  v_smfmac_f32_32x32x32_bf16 v[128:143], v[32:35], v[96:103], v9
  s_waitcnt lgkmcnt(0)
  v_exp_f32 v107, v107
  v_exp_f32 v108, v108
  v_exp_f32 v109, v109
  v_exp_f32 v110, v110
  v_exp_f32 v111, v111
  v_exp_f32 v80, v80
  v_exp_f32 v81, v81
  v_exp_f32 v82, v82
  v_smfmac_f32_32x32x32_bf16 v[128:143], v[36:39], v[104:111], v9
  v_exp_f32 v83, v83
  v_exp_f32 v84, v84
  v_exp_f32 v85, v85
  v_mfma_f32_32x32x16_bf16 v[96:111], v[28:31], v[20:23], v[64:79]
  v_exp_f32 v86, v86
  v_exp_f32 v87, v87
  v_exp_f32 v88, v88
  v_exp_f32 v89, v89
  v_exp_f32 v90, v90
  v_smfmac_f32_32x32x32_bf16 v[112:127], v[40:43], v[80:87], v9
  s_mov_b64 exec, s[44:45]
  ds_read_b128 v[32:35], v7 offset:4096
  ds_read_b128 v[36:39], v7 offset:4608
  s_mov_b64 exec, -1
  ds_read_b128 v[28:31], v6 offset:5120
  v_exp_f32 v91, v91
  v_exp_f32 v92, v92
  v_exp_f32 v93, v93
  v_exp_f32 v94, v94
  v_exp_f32 v95, v95
  v_exp_f32 v96, v96
  v_exp_f32 v97, v97
  v_exp_f32 v98, v98
  v_smfmac_f32_32x32x32_bf16 v[112:127], v[44:47], v[88:95], v9
  v_exp_f32 v99, v99
  v_exp_f32 v100, v100
  v_exp_f32 v101, v101
  v_mfma_f32_32x32x16_bf16 v[80:95], v[24:27], v[16:19], v[48:63]
  v_exp_f32 v102, v102
  v_exp_f32 v103, v103
  v_exp_f32 v104, v104
  v_exp_f32 v105, v105
  v_exp_f32 v106, v106
  v_smfmac_f32_32x32x32_bf16 v[128:143], v[40:43], v[96:103], v9
  s_waitcnt lgkmcnt(0)
  v_exp_f32 v107, v107
  v_exp_f32 v108, v108
  v_exp_f32 v109, v109
  v_exp_f32 v110, v110
  v_exp_f32 v111, v111
  v_exp_f32 v80, v80
  v_exp_f32 v81, v81
  v_exp_f32 v82, v82
  v_smfmac_f32_32x32x32_bf16 v[128:143], v[44:47], v[104:111], v9
  v_exp_f32 v83, v83
  v_exp_f32 v84, v84
  v_exp_f32 v85, v85
  v_mfma_f32_32x32x16_bf16 v[96:111], v[24:27], v[20:23], v[64:79]
  v_exp_f32 v86, v86
  v_exp_f32 v87, v87
  v_exp_f32 v88, v88
  v_exp_f32 v89, v89
  v_exp_f32 v90, v90
  v_smfmac_f32_32x32x32_bf16 v[112:127], v[32:35], v[80:87], v9
  s_mov_b64 exec, s[44:45]
  ds_read_b128 v[40:43], v7 offset:5120
  ds_read_b128 v[44:47], v7 offset:5632
  s_mov_b64 exec, -1
  ds_read_b128 v[24:27], v6 offset:6144
  v_exp_f32 v91, v91
  v_exp_f32 v92, v92
  v_exp_f32 v93, v93
  v_exp_f32 v94, v94
  v_exp_f32 v95, v95
  v_exp_f32 v96, v96
  v_exp_f32 v97, v97
  v_exp_f32 v98, v98
  v_smfmac_f32_32x32x32_bf16 v[112:127], v[36:39], v[88:95], v9
  v_exp_f32 v99, v99
  v_exp_f32 v100, v100
  v_exp_f32 v101, v101
  v_mfma_f32_32x32x16_bf16 v[80:95], v[28:31], v[16:19], v[48:63]
  v_exp_f32 v102, v102
  v_exp_f32 v103, v103
  v_exp_f32 v104, v104
  v_exp_f32 v105, v105
  v_exp_f32 v106, v106
  v_smfmac_f32_32x32x32_bf16 v[128:143], v[32:35], v[96:103], v9
  s_waitcnt lgkmcnt(0)
  v_exp_f32 v107, v107
  v_exp_f32 v108, v108
  v_exp_f32 v109, v109
  v_exp_f32 v110, v110
  v_exp_f32 v111, v111
  v_exp_f32 v80, v80
  v_exp_f32 v81, v81
  v_exp_f32 v82, v82
  v_smfmac_f32_32x32x32_bf16 v[128:143], v[36:39], v[104:111], v9
  v_exp_f32 v83, v83
  v_exp_f32 v84, v84
  v_exp_f32 v85, v85
  v_mfma_f32_32x32x16_bf16 v[96:111], v[28:31], v[20:23], v[64:79]
  v_exp_f32 v86, v86
  v_exp_f32 v87, v87
  v_exp_f32 v88, v88
  v_exp_f32 v89, v89
  v_exp_f32 v90, v90
  v_smfmac_f32_32x32x32_bf16 v[112:127], v[40:43], v[80:87], v9
  s_mov_b64 exec, s[44:45]
  ds_read_b128 v[32:35], v7 offset:6144
  ds_read_b128 v[36:39], v7 offset:6656
  s_mov_b64 exec, -1
  ds_read_b128 v[28:31], v6 offset:7168
  v_exp_f32 v91, v91
  v_exp_f32 v92, v92
  v_exp_f32 v93, v93
  v_exp_f32 v94, v94
  v_exp_f32 v95, v95
  v_exp_f32 v96, v96
  v_exp_f32 v97, v97
  v_exp_f32 v98, v98
  v_smfmac_f32_32x32x32_bf16 v[112:127], v[44:47], v[88:95], v9
  v_exp_f32 v99, v99
  v_exp_f32 v100, v100
  v_exp_f32 v101, v101
  v_mfma_f32_32x32x16_bf16 v[80:95], v[24:27], v[16:19], v[48:63]
  v_exp_f32 v102, v102
  v_exp_f32 v103, v103
  v_exp_f32 v104, v104
  v_exp_f32 v105, v105
  v_exp_f32 v106, v106
  v_smfmac_f32_32x32x32_bf16 v[128:143], v[40:43], v[96:103], v9
  s_waitcnt lgkmcnt(0)
  v_exp_f32 v107, v107
  v_exp_f32 v108, v108
  v_exp_f32 v109, v109
  v_exp_f32 v110, v110
  v_exp_f32 v111, v111
  v_exp_f32 v80, v80
  v_exp_f32 v81, v81
  v_exp_f32 v82, v82
  v_smfmac_f32_32x32x32_bf16 v[128:143], v[44:47], v[104:111], v9
  v_exp_f32 v83, v83
  v_exp_f32 v84, v84
  v_exp_f32 v85, v85
  v_mfma_f32_32x32x16_bf16 v[96:111], v[24:27], v[20:23], v[64:79]
  v_exp_f32 v86, v86
  v_exp_f32 v87, v87
  v_exp_f32 v88, v88
  v_exp_f32 v89, v89
  v_exp_f32 v90, v90
  v_smfmac_f32_32x32x32_bf16 v[112:127], v[32:35], v[80:87], v9
  s_waitcnt vmcnt(4)
  s_barrier
  s_add_u32 s48, s51, 56
  s_and_b32 s48, s48, 63
  s_lshl_b32 s48, s48, 11
  s_add_u32 s48, s48, s46
  s_add_u32 m0, s47, 24576
  s_add_u32 s39, s48, 1024
  buffer_load_dwordx4 v5, s[12:15], s48 offen sc1 lds
  s_add_u32 m0, s47, 90112
  s_nop 0
  buffer_load_dwordx4 v5, s[12:15], s39 offen sc1 lds
  s_add_u32 s48, s51, 57
  s_and_b32 s48, s48, 63
  s_lshl_b32 s48, s48, 11
  s_add_u32 s48, s48, s46
  s_add_u32 m0, s47, 25600
  s_add_u32 s39, s48, 1024
  buffer_load_dwordx4 v5, s[12:15], s48 offen sc1 lds
  s_add_u32 m0, s47, 91136
  s_nop 0
  buffer_load_dwordx4 v5, s[12:15], s39 offen sc1 lds
  s_mov_b64 exec, s[44:45]
  ds_read_b128 v[40:43], v7 offset:7168
  ds_read_b128 v[44:47], v7 offset:7680
  s_mov_b64 exec, -1
  ds_read_b128 v[24:27], v6 offset:8192
  v_exp_f32 v91, v91
  v_exp_f32 v92, v92
  v_exp_f32 v93, v93
  v_exp_f32 v94, v94
  v_exp_f32 v95, v95
  v_exp_f32 v96, v96
  v_exp_f32 v97, v97
  v_exp_f32 v98, v98
  v_smfmac_f32_32x32x32_bf16 v[112:127], v[36:39], v[88:95], v9
  v_exp_f32 v99, v99
  v_exp_f32 v100, v100
  v_exp_f32 v101, v101
  v_mfma_f32_32x32x16_bf16 v[80:95], v[28:31], v[16:19], v[48:63]
  v_exp_f32 v102, v102
  v_exp_f32 v103, v103
  v_exp_f32 v104, v104
  v_exp_f32 v105, v105
  v_exp_f32 v106, v106
  v_smfmac_f32_32x32x32_bf16 v[128:143], v[32:35], v[96:103], v9
  s_waitcnt lgkmcnt(0)
  v_exp_f32 v107, v107
  v_exp_f32 v108, v108
  v_exp_f32 v109, v109
  v_exp_f32 v110, v110
  v_exp_f32 v111, v111
  v_exp_f32 v80, v80
  v_exp_f32 v81, v81
  v_exp_f32 v82, v82
  v_smfmac_f32_32x32x32_bf16 v[128:143], v[36:39], v[104:111], v9
  v_exp_f32 v83, v83
  v_exp_f32 v84, v84
  v_exp_f32 v85, v85
  v_mfma_f32_32x32x16_bf16 v[96:111], v[28:31], v[20:23], v[64:79]
  v_exp_f32 v86, v86
  v_exp_f32 v87, v87
  v_exp_f32 v88, v88
  v_exp_f32 v89, v89
  v_exp_f32 v90, v90
  v_smfmac_f32_32x32x32_bf16 v[112:127], v[40:43], v[80:87], v9
  s_mov_b64 exec, s[44:45]
  ds_read_b128 v[32:35], v7 offset:8192
  ds_read_b128 v[36:39], v7 offset:8704
  s_mov_b64 exec, -1
  ds_read_b128 v[28:31], v6 offset:9216
  v_exp_f32 v91, v91
  v_exp_f32 v92, v92
  v_exp_f32 v93, v93
  v_exp_f32 v94, v94
  v_exp_f32 v95, v95
  v_exp_f32 v96, v96
  v_exp_f32 v97, v97
  v_exp_f32 v98, v98
  v_smfmac_f32_32x32x32_bf16 v[112:127], v[44:47], v[88:95], v9
  v_exp_f32 v99, v99
  v_exp_f32 v100, v100
  v_exp_f32 v101, v101
  v_mfma_f32_32x32x16_bf16 v[80:95], v[24:27], v[16:19], v[48:63]
  v_exp_f32 v102, v102
  v_exp_f32 v103, v103
  v_exp_f32 v104, v104
  v_exp_f32 v105, v105
  v_exp_f32 v106, v106
  v_smfmac_f32_32x32x32_bf16 v[128:143], v[40:43], v[96:103], v9
  s_waitcnt lgkmcnt(0)
  v_exp_f32 v107, v107
  v_exp_f32 v108, v108
  v_exp_f32 v109, v109
  v_exp_f32 v110, v110
  v_exp_f32 v111, v111
  v_exp_f32 v80, v80
  v_exp_f32 v81, v81
  v_exp_f32 v82, v82
  v_smfmac_f32_32x32x32_bf16 v[128:143], v[44:47], v[104:111], v9
  v_exp_f32 v83, v83
  v_exp_f32 v84, v84
  v_exp_f32 v85, v85
  v_mfma_f32_32x32x16_bf16 v[96:111], v[24:27], v[20:23], v[64:79]
  v_exp_f32 v86, v86
  v_exp_f32 v87, v87
  v_exp_f32 v88, v88
  v_exp_f32 v89, v89
  v_exp_f32 v90, v90
  v_smfmac_f32_32x32x32_bf16 v[112:127], v[32:35], v[80:87], v9
  s_mov_b64 exec, s[44:45]
  ds_read_b128 v[40:43], v7 offset:9216
  ds_read_b128 v[44:47], v7 offset:9728
  s_mov_b64 exec, -1
  ds_read_b128 v[24:27], v6 offset:10240
  v_exp_f32 v91, v91
  v_exp_f32 v92, v92
  v_exp_f32 v93, v93
  v_exp_f32 v94, v94
  v_exp_f32 v95, v95
  v_exp_f32 v96, v96
  v_exp_f32 v97, v97
  v_exp_f32 v98, v98
  v_smfmac_f32_32x32x32_bf16 v[112:127], v[36:39], v[88:95], v9
  v_exp_f32 v99, v99
  v_exp_f32 v100, v100
  v_exp_f32 v101, v101
  v_mfma_f32_32x32x16_bf16 v[80:95], v[28:31], v[16:19], v[48:63]
  v_exp_f32 v102, v102
  v_exp_f32 v103, v103
  v_exp_f32 v104, v104
  v_exp_f32 v105, v105
  v_exp_f32 v106, v106
  v_smfmac_f32_32x32x32_bf16 v[128:143], v[32:35], v[96:103], v9
  s_waitcnt lgkmcnt(0)
  v_exp_f32 v107, v107
  v_exp_f32 v108, v108
  v_exp_f32 v109, v109
  v_exp_f32 v110, v110
  v_exp_f32 v111, v111
  v_exp_f32 v80, v80
  v_exp_f32 v81, v81
  v_exp_f32 v82, v82
  v_smfmac_f32_32x32x32_bf16 v[128:143], v[36:39], v[104:111], v9
  v_exp_f32 v83, v83
  v_exp_f32 v84, v84
  v_exp_f32 v85, v85
  v_mfma_f32_32x32x16_bf16 v[96:111], v[28:31], v[20:23], v[64:79]
  v_exp_f32 v86, v86
  v_exp_f32 v87, v87
  v_exp_f32 v88, v88
  v_exp_f32 v89, v89
  v_exp_f32 v90, v90
  v_smfmac_f32_32x32x32_bf16 v[112:127], v[40:43], v[80:87], v9
  s_mov_b64 exec, s[44:45]
  ds_read_b128 v[32:35], v7 offset:10240
  ds_read_b128 v[36:39], v7 offset:10752
  s_mov_b64 exec, -1
  ds_read_b128 v[28:31], v6 offset:11264
  v_exp_f32 v91, v91
  v_exp_f32 v92, v92
  v_exp_f32 v93, v93
  v_exp_f32 v94, v94
  v_exp_f32 v95, v95
  v_exp_f32 v96, v96
  v_exp_f32 v97, v97
  v_exp_f32 v98, v98
  v_smfmac_f32_32x32x32_bf16 v[112:127], v[44:47], v[88:95], v9
  v_exp_f32 v99, v99
  v_exp_f32 v100, v100
  v_exp_f32 v101, v101
  v_mfma_f32_32x32x16_bf16 v[80:95], v[24:27], v[16:19], v[48:63]
  v_exp_f32 v102, v102
  v_exp_f32 v103, v103
  v_exp_f32 v104, v104
  v_exp_f32 v105, v105
  v_exp_f32 v106, v106
  v_smfmac_f32_32x32x32_bf16 v[128:143], v[40:43], v[96:103], v9
  s_waitcnt lgkmcnt(0)
  v_exp_f32 v107, v107
  v_exp_f32 v108, v108
  v_exp_f32 v109, v109
  v_exp_f32 v110, v110
  v_exp_f32 v111, v111
  v_exp_f32 v80, v80
  v_exp_f32 v81, v81
  v_exp_f32 v82, v82
  v_smfmac_f32_32x32x32_bf16 v[128:143], v[44:47], v[104:111], v9
  v_exp_f32 v83, v83
  v_exp_f32 v84, v84
  v_exp_f32 v85, v85
  v_mfma_f32_32x32x16_bf16 v[96:111], v[24:27], v[20:23], v[64:79]
  v_exp_f32 v86, v86
  v_exp_f32 v87, v87
  v_exp_f32 v88, v88
  v_exp_f32 v89, v89
  v_exp_f32 v90, v90
  v_smfmac_f32_32x32x32_bf16 v[112:127], v[32:35], v[80:87], v9
  s_mov_b64 exec, s[44:45]
  ds_read_b128 v[40:43], v7 offset:11264
  ds_read_b128 v[44:47], v7 offset:11776
  s_mov_b64 exec, -1
  ds_read_b128 v[24:27], v6 offset:12288
  v_exp_f32 v91, v91
  v_exp_f32 v92, v92
  v_exp_f32 v93, v93
  v_exp_f32 v94, v94
  v_exp_f32 v95, v95
  v_exp_f32 v96, v96
  v_exp_f32 v97, v97
  v_exp_f32 v98, v98
  v_smfmac_f32_32x32x32_bf16 v[112:127], v[36:39], v[88:95], v9
  v_exp_f32 v99, v99
  v_exp_f32 v100, v100
  v_exp_f32 v101, v101
  v_mfma_f32_32x32x16_bf16 v[80:95], v[28:31], v[16:19], v[48:63]
  v_exp_f32 v102, v102
  v_exp_f32 v103, v103
  v_exp_f32 v104, v104
  v_exp_f32 v105, v105
  v_exp_f32 v106, v106
  v_smfmac_f32_32x32x32_bf16 v[128:143], v[32:35], v[96:103], v9
  s_waitcnt lgkmcnt(0)
  v_exp_f32 v107, v107
  v_exp_f32 v108, v108
  v_exp_f32 v109, v109
  v_exp_f32 v110, v110
  v_exp_f32 v111, v111
  v_exp_f32 v80, v80
  v_exp_f32 v81, v81
  v_exp_f32 v82, v82
  v_smfmac_f32_32x32x32_bf16 v[128:143], v[36:39], v[104:111], v9
  v_exp_f32 v83, v83
  v_exp_f32 v84, v84
  v_exp_f32 v85, v85
  v_mfma_f32_32x32x16_bf16 v[96:111], v[28:31], v[20:23], v[64:79]
  v_exp_f32 v86, v86
  v_exp_f32 v87, v87
  v_exp_f32 v88, v88
  v_exp_f32 v89, v89
  v_exp_f32 v90, v90
  v_smfmac_f32_32x32x32_bf16 v[112:127], v[40:43], v[80:87], v9
  s_mov_b64 exec, s[44:45]
  ds_read_b128 v[32:35], v7 offset:12288
  ds_read_b128 v[36:39], v7 offset:12800
  s_mov_b64 exec, -1
  ds_read_b128 v[28:31], v6 offset:13312
  v_exp_f32 v91, v91
  v_exp_f32 v92, v92
  v_exp_f32 v93, v93
  v_exp_f32 v94, v94
  v_exp_f32 v95, v95
  v_exp_f32 v96, v96
  v_exp_f32 v97, v97
  v_exp_f32 v98, v98
  v_smfmac_f32_32x32x32_bf16 v[112:127], v[44:47], v[88:95], v9
  v_exp_f32 v99, v99
  v_exp_f32 v100, v100
  v_exp_f32 v101, v101
  v_mfma_f32_32x32x16_bf16 v[80:95], v[24:27], v[16:19], v[48:63]
  v_exp_f32 v102, v102
  v_exp_f32 v103, v103
  v_exp_f32 v104, v104
  v_exp_f32 v105, v105
  v_exp_f32 v106, v106
  v_smfmac_f32_32x32x32_bf16 v[128:143], v[40:43], v[96:103], v9
  s_waitcnt lgkmcnt(0)
  v_exp_f32 v107, v107
  v_exp_f32 v108, v108
  v_exp_f32 v109, v109
  v_exp_f32 v110, v110
  v_exp_f32 v111, v111
  v_exp_f32 v80, v80
  v_exp_f32 v81, v81
  v_exp_f32 v82, v82
  v_smfmac_f32_32x32x32_bf16 v[128:143], v[44:47], v[104:111], v9
  v_exp_f32 v83, v83
  v_exp_f32 v84, v84
  v_exp_f32 v85, v85
  v_mfma_f32_32x32x16_bf16 v[96:111], v[24:27], v[20:23], v[64:79]
  v_exp_f32 v86, v86
  v_exp_f32 v87, v87
  v_exp_f32 v88, v88
  v_exp_f32 v89, v89
  v_exp_f32 v90, v90
  v_smfmac_f32_32x32x32_bf16 v[112:127], v[32:35], v[80:87], v9
  s_mov_b64 exec, s[44:45]
  ds_read_b128 v[40:43], v7 offset:13312
  ds_read_b128 v[44:47], v7 offset:13824
  s_mov_b64 exec, -1
  ds_read_b128 v[24:27], v6 offset:14336
  v_exp_f32 v91, v91
  v_exp_f32 v92, v92
  v_exp_f32 v93, v93
  v_exp_f32 v94, v94
  v_exp_f32 v95, v95
  v_exp_f32 v96, v96
  v_exp_f32 v97, v97
  v_exp_f32 v98, v98
  v_smfmac_f32_32x32x32_bf16 v[112:127], v[36:39], v[88:95], v9
  v_exp_f32 v99, v99
  v_exp_f32 v100, v100
  v_exp_f32 v101, v101
  v_mfma_f32_32x32x16_bf16 v[80:95], v[28:31], v[16:19], v[48:63]
  v_exp_f32 v102, v102
  v_exp_f32 v103, v103
  v_exp_f32 v104, v104
  v_exp_f32 v105, v105
  v_exp_f32 v106, v106
  v_smfmac_f32_32x32x32_bf16 v[128:143], v[32:35], v[96:103], v9
  s_waitcnt lgkmcnt(0)
  v_exp_f32 v107, v107
  v_exp_f32 v108, v108
  v_exp_f32 v109, v109
  v_exp_f32 v110, v110
  v_exp_f32 v111, v111
  v_exp_f32 v80, v80
  v_exp_f32 v81, v81
  v_exp_f32 v82, v82
  v_smfmac_f32_32x32x32_bf16 v[128:143], v[36:39], v[104:111], v9
  v_exp_f32 v83, v83
  v_exp_f32 v84, v84
  v_exp_f32 v85, v85
  v_mfma_f32_32x32x16_bf16 v[96:111], v[28:31], v[20:23], v[64:79]
  v_exp_f32 v86, v86
  v_exp_f32 v87, v87
  v_exp_f32 v88, v88
  v_exp_f32 v89, v89
  v_exp_f32 v90, v90
  v_smfmac_f32_32x32x32_bf16 v[112:127], v[40:43], v[80:87], v9
  s_mov_b64 exec, s[44:45]
  ds_read_b128 v[32:35], v7 offset:14336
  ds_read_b128 v[36:39], v7 offset:14848
  s_mov_b64 exec, -1
  ds_read_b128 v[28:31], v6 offset:15360
  v_exp_f32 v91, v91
  v_exp_f32 v92, v92
  v_exp_f32 v93, v93
  v_exp_f32 v94, v94
  v_exp_f32 v95, v95
  v_exp_f32 v96, v96
  v_exp_f32 v97, v97
  v_exp_f32 v98, v98
  v_smfmac_f32_32x32x32_bf16 v[112:127], v[44:47], v[88:95], v9
  v_exp_f32 v99, v99
  v_exp_f32 v100, v100
  v_exp_f32 v101, v101
  v_mfma_f32_32x32x16_bf16 v[80:95], v[24:27], v[16:19], v[48:63]
  v_exp_f32 v102, v102
  v_exp_f32 v103, v103
  v_exp_f32 v104, v104
  v_exp_f32 v105, v105
  v_exp_f32 v106, v106
  v_smfmac_f32_32x32x32_bf16 v[128:143], v[40:43], v[96:103], v9
  s_waitcnt lgkmcnt(0)
  v_exp_f32 v107, v107
  v_exp_f32 v108, v108
  v_exp_f32 v109, v109
  v_exp_f32 v110, v110
  v_exp_f32 v111, v111
  v_exp_f32 v80, v80
  v_exp_f32 v81, v81
  v_exp_f32 v82, v82
  v_smfmac_f32_32x32x32_bf16 v[128:143], v[44:47], v[104:111], v9
  v_exp_f32 v83, v83
  v_exp_f32 v84, v84
  v_exp_f32 v85, v85
  v_mfma_f32_32x32x16_bf16 v[96:111], v[24:27], v[20:23], v[64:79]
  v_exp_f32 v86, v86
  v_exp_f32 v87, v87
  v_exp_f32 v88, v88
  v_exp_f32 v89, v89
  v_exp_f32 v90, v90
  v_smfmac_f32_32x32x32_bf16 v[112:127], v[32:35], v[80:87], v9
  s_waitcnt vmcnt(4)
  s_barrier
  s_add_u32 m0, s58, 0
  s_add_u32 s48, s56, 131072
  buffer_load_dwordx4 v152, s[4:7], s48 offen lds
  s_add_u32 m0, s58, 1024
  s_add_u32 s48, s56, 139264
  buffer_load_dwordx4 v152, s[4:7], s48 offen lds
  s_add_u32 m0, s58, 2048
  s_add_u32 s48, s56, 147456
  buffer_load_dwordx4 v152, s[4:7], s48 offen lds
  s_add_u32 m0, s58, 3072
  s_add_u32 s48, s56, 155648
  buffer_load_dwordx4 v152, s[4:7], s48 offen lds
  s_mov_b64 exec, s[44:45]
  ds_read_b128 v[40:43], v7 offset:15360
  ds_read_b128 v[44:47], v7 offset:15872
  s_mov_b64 exec, -1
  ds_read_b128 v[24:27], v6 offset:16384
  v_exp_f32 v91, v91
  v_exp_f32 v92, v92
  v_exp_f32 v93, v93
  v_exp_f32 v94, v94
  v_exp_f32 v95, v95
  v_exp_f32 v96, v96
  v_exp_f32 v97, v97
  v_exp_f32 v98, v98
  v_smfmac_f32_32x32x32_bf16 v[112:127], v[36:39], v[88:95], v9
  v_exp_f32 v99, v99
  v_exp_f32 v100, v100
  v_exp_f32 v101, v101
  v_mfma_f32_32x32x16_bf16 v[80:95], v[28:31], v[16:19], v[48:63]
  v_exp_f32 v102, v102
  v_exp_f32 v103, v103
  v_exp_f32 v104, v104
  v_exp_f32 v105, v105
  v_exp_f32 v106, v106
  v_smfmac_f32_32x32x32_bf16 v[128:143], v[32:35], v[96:103], v9
  s_waitcnt lgkmcnt(0)
  v_exp_f32 v107, v107
  v_exp_f32 v108, v108
  v_exp_f32 v109, v109
  v_exp_f32 v110, v110
  v_exp_f32 v111, v111
  v_exp_f32 v80, v80
  v_exp_f32 v81, v81
  v_exp_f32 v82, v82
  v_smfmac_f32_32x32x32_bf16 v[128:143], v[36:39], v[104:111], v9
  v_exp_f32 v83, v83
  v_exp_f32 v84, v84
  v_exp_f32 v85, v85
  v_mfma_f32_32x32x16_bf16 v[96:111], v[28:31], v[20:23], v[64:79]
  v_exp_f32 v86, v86
  v_exp_f32 v87, v87
  v_exp_f32 v88, v88
  v_exp_f32 v89, v89
  v_exp_f32 v90, v90
  v_smfmac_f32_32x32x32_bf16 v[112:127], v[40:43], v[80:87], v9
  s_mov_b64 exec, s[44:45]
  ds_read_b128 v[32:35], v7 offset:16384
  ds_read_b128 v[36:39], v7 offset:16896
  s_mov_b64 exec, -1
  ds_read_b128 v[28:31], v6 offset:17408
  v_exp_f32 v91, v91
  v_exp_f32 v92, v92
  v_exp_f32 v93, v93
  v_exp_f32 v94, v94
  v_exp_f32 v95, v95
  v_exp_f32 v96, v96
  v_exp_f32 v97, v97
  v_exp_f32 v98, v98
  v_smfmac_f32_32x32x32_bf16 v[112:127], v[44:47], v[88:95], v9
  v_exp_f32 v99, v99
  v_exp_f32 v100, v100
  v_exp_f32 v101, v101
  v_mfma_f32_32x32x16_bf16 v[80:95], v[24:27], v[16:19], v[48:63]
  v_exp_f32 v102, v102
  v_exp_f32 v103, v103
  v_exp_f32 v104, v104
  v_exp_f32 v105, v105
  v_exp_f32 v106, v106
  v_smfmac_f32_32x32x32_bf16 v[128:143], v[40:43], v[96:103], v9
  s_waitcnt lgkmcnt(0)
  v_exp_f32 v107, v107
  v_exp_f32 v108, v108
  v_exp_f32 v109, v109
  v_exp_f32 v110, v110
  v_exp_f32 v111, v111
  v_exp_f32 v80, v80
  v_exp_f32 v81, v81
  v_exp_f32 v82, v82
  v_smfmac_f32_32x32x32_bf16 v[128:143], v[44:47], v[104:111], v9
  v_exp_f32 v83, v83
  v_exp_f32 v84, v84
  v_exp_f32 v85, v85
  v_mfma_f32_32x32x16_bf16 v[96:111], v[24:27], v[20:23], v[64:79]
  v_exp_f32 v86, v86
  v_exp_f32 v87, v87
  v_exp_f32 v88, v88
  v_exp_f32 v89, v89
  v_exp_f32 v90, v90
  v_smfmac_f32_32x32x32_bf16 v[112:127], v[32:35], v[80:87], v9
  s_mov_b64 exec, s[44:45]
  ds_read_b128 v[40:43], v7 offset:17408
  ds_read_b128 v[44:47], v7 offset:17920
  s_mov_b64 exec, -1
  ds_read_b128 v[24:27], v6 offset:18432
  v_exp_f32 v91, v91
  v_exp_f32 v92, v92
  v_exp_f32 v93, v93
  v_exp_f32 v94, v94
  v_exp_f32 v95, v95
  v_exp_f32 v96, v96
  v_exp_f32 v97, v97
  v_exp_f32 v98, v98
  v_smfmac_f32_32x32x32_bf16 v[112:127], v[36:39], v[88:95], v9
  v_exp_f32 v99, v99
  v_exp_f32 v100, v100
  v_exp_f32 v101, v101
  v_mfma_f32_32x32x16_bf16 v[80:95], v[28:31], v[16:19], v[48:63]
  v_exp_f32 v102, v102
  v_exp_f32 v103, v103
  v_exp_f32 v104, v104
  v_exp_f32 v105, v105
  v_exp_f32 v106, v106
  v_smfmac_f32_32x32x32_bf16 v[128:143], v[32:35], v[96:103], v9
  s_waitcnt lgkmcnt(0)
  v_exp_f32 v107, v107
  v_exp_f32 v108, v108
  v_exp_f32 v109, v109
  v_exp_f32 v110, v110
  v_exp_f32 v111, v111
  v_exp_f32 v80, v80
  v_exp_f32 v81, v81
  v_exp_f32 v82, v82
  v_smfmac_f32_32x32x32_bf16 v[128:143], v[36:39], v[104:111], v9
  v_exp_f32 v83, v83
  v_exp_f32 v84, v84
  v_exp_f32 v85, v85
  v_mfma_f32_32x32x16_bf16 v[96:111], v[28:31], v[20:23], v[64:79]
  v_exp_f32 v86, v86
  v_exp_f32 v87, v87
  v_exp_f32 v88, v88
  v_exp_f32 v89, v89
  v_exp_f32 v90, v90
  v_smfmac_f32_32x32x32_bf16 v[112:127], v[40:43], v[80:87], v9
  s_mov_b64 exec, s[44:45]
  ds_read_b128 v[32:35], v7 offset:18432
  ds_read_b128 v[36:39], v7 offset:18944
  s_mov_b64 exec, -1
  ds_read_b128 v[28:31], v6 offset:19456
  v_exp_f32 v91, v91
  v_exp_f32 v92, v92
  v_exp_f32 v93, v93
  v_exp_f32 v94, v94
  v_exp_f32 v95, v95
  v_exp_f32 v96, v96
  v_exp_f32 v97, v97
  v_exp_f32 v98, v98
  v_smfmac_f32_32x32x32_bf16 v[112:127], v[44:47], v[88:95], v9
  v_exp_f32 v99, v99
  v_exp_f32 v100, v100
  v_exp_f32 v101, v101
  v_mfma_f32_32x32x16_bf16 v[80:95], v[24:27], v[16:19], v[48:63]
  v_exp_f32 v102, v102
  v_exp_f32 v103, v103
  v_exp_f32 v104, v104
  v_exp_f32 v105, v105
  v_exp_f32 v106, v106
  v_smfmac_f32_32x32x32_bf16 v[128:143], v[40:43], v[96:103], v9
  s_waitcnt lgkmcnt(0)
  v_exp_f32 v107, v107
  v_exp_f32 v108, v108
  v_exp_f32 v109, v109
  v_exp_f32 v110, v110
  v_exp_f32 v111, v111
  v_exp_f32 v80, v80
  v_exp_f32 v81, v81
  v_exp_f32 v82, v82
  v_smfmac_f32_32x32x32_bf16 v[128:143], v[44:47], v[104:111], v9
  v_exp_f32 v83, v83
  v_exp_f32 v84, v84
  v_exp_f32 v85, v85
  v_mfma_f32_32x32x16_bf16 v[96:111], v[24:27], v[20:23], v[64:79]
  v_exp_f32 v86, v86
  v_exp_f32 v87, v87
  v_exp_f32 v88, v88
  v_exp_f32 v89, v89
  v_exp_f32 v90, v90
  v_smfmac_f32_32x32x32_bf16 v[112:127], v[32:35], v[80:87], v9
  s_mov_b64 exec, s[44:45]
  ds_read_b128 v[40:43], v7 offset:19456
  ds_read_b128 v[44:47], v7 offset:19968
  s_mov_b64 exec, -1
  ds_read_b128 v[24:27], v6 offset:20480
  v_exp_f32 v91, v91
  v_exp_f32 v92, v92
  v_exp_f32 v93, v93
  v_exp_f32 v94, v94
  v_exp_f32 v95, v95
  v_exp_f32 v96, v96
  v_exp_f32 v97, v97
  v_exp_f32 v98, v98
  v_smfmac_f32_32x32x32_bf16 v[112:127], v[36:39], v[88:95], v9
  v_exp_f32 v99, v99
  v_exp_f32 v100, v100
  v_exp_f32 v101, v101
  v_mfma_f32_32x32x16_bf16 v[80:95], v[28:31], v[16:19], v[48:63]
  v_exp_f32 v102, v102
  v_exp_f32 v103, v103
  v_exp_f32 v104, v104
  v_exp_f32 v105, v105
  v_exp_f32 v106, v106
  v_smfmac_f32_32x32x32_bf16 v[128:143], v[32:35], v[96:103], v9
  s_waitcnt lgkmcnt(0)
  v_exp_f32 v107, v107
  v_exp_f32 v108, v108
  v_exp_f32 v109, v109
  v_exp_f32 v110, v110
  v_exp_f32 v111, v111
  v_exp_f32 v80, v80
  v_exp_f32 v81, v81
  v_exp_f32 v82, v82
  v_smfmac_f32_32x32x32_bf16 v[128:143], v[36:39], v[104:111], v9
  v_exp_f32 v83, v83
  v_exp_f32 v84, v84
  v_exp_f32 v85, v85
  v_mfma_f32_32x32x16_bf16 v[96:111], v[28:31], v[20:23], v[64:79]
  v_exp_f32 v86, v86
  v_exp_f32 v87, v87
  v_exp_f32 v88, v88
  v_exp_f32 v89, v89
  v_exp_f32 v90, v90
  v_smfmac_f32_32x32x32_bf16 v[112:127], v[40:43], v[80:87], v9
  s_mov_b64 exec, s[44:45]
  ds_read_b128 v[32:35], v7 offset:20480
  ds_read_b128 v[36:39], v7 offset:20992
  s_mov_b64 exec, -1
  ds_read_b128 v[28:31], v6 offset:21504
  v_exp_f32 v91, v91
  v_exp_f32 v92, v92
  v_exp_f32 v93, v93
  v_exp_f32 v94, v94
  v_exp_f32 v95, v95
  v_exp_f32 v96, v96
  v_exp_f32 v97, v97
  v_exp_f32 v98, v98
  v_smfmac_f32_32x32x32_bf16 v[112:127], v[44:47], v[88:95], v9
  v_exp_f32 v99, v99
  v_exp_f32 v100, v100
  v_exp_f32 v101, v101
  v_mfma_f32_32x32x16_bf16 v[80:95], v[24:27], v[16:19], v[48:63]
  v_exp_f32 v102, v102
  v_exp_f32 v103, v103
  v_exp_f32 v104, v104
  v_exp_f32 v105, v105
  v_exp_f32 v106, v106
  v_smfmac_f32_32x32x32_bf16 v[128:143], v[40:43], v[96:103], v9
  s_waitcnt lgkmcnt(0)
  v_exp_f32 v107, v107
  v_exp_f32 v108, v108
  v_exp_f32 v109, v109
  v_exp_f32 v110, v110
  v_exp_f32 v111, v111
  v_exp_f32 v80, v80
  v_exp_f32 v81, v81
  v_exp_f32 v82, v82
  v_smfmac_f32_32x32x32_bf16 v[128:143], v[44:47], v[104:111], v9
  v_exp_f32 v83, v83
  v_exp_f32 v84, v84
  v_exp_f32 v85, v85
  v_mfma_f32_32x32x16_bf16 v[96:111], v[24:27], v[20:23], v[64:79]
  v_exp_f32 v86, v86
  v_exp_f32 v87, v87
  v_exp_f32 v88, v88
  v_exp_f32 v89, v89
  v_exp_f32 v90, v90
  v_smfmac_f32_32x32x32_bf16 v[112:127], v[32:35], v[80:87], v9
  s_mov_b64 exec, s[44:45]
  ds_read_b128 v[40:43], v7 offset:21504
  ds_read_b128 v[44:47], v7 offset:22016
  s_mov_b64 exec, -1
  ds_read_b128 v[24:27], v6 offset:22528
  v_exp_f32 v91, v91
  v_exp_f32 v92, v92
  v_exp_f32 v93, v93
  v_exp_f32 v94, v94
  v_exp_f32 v95, v95
  v_exp_f32 v96, v96
  v_exp_f32 v97, v97
  v_exp_f32 v98, v98
  v_smfmac_f32_32x32x32_bf16 v[112:127], v[36:39], v[88:95], v9
  v_exp_f32 v99, v99
  v_exp_f32 v100, v100
  v_exp_f32 v101, v101
  v_mfma_f32_32x32x16_bf16 v[80:95], v[28:31], v[16:19], v[48:63]
  v_exp_f32 v102, v102
  v_exp_f32 v103, v103
  v_exp_f32 v104, v104
  v_exp_f32 v105, v105
  v_exp_f32 v106, v106
  v_smfmac_f32_32x32x32_bf16 v[128:143], v[32:35], v[96:103], v9
  s_waitcnt lgkmcnt(0)
  v_exp_f32 v107, v107
  v_exp_f32 v108, v108
  v_exp_f32 v109, v109
  v_exp_f32 v110, v110
  v_exp_f32 v111, v111
  v_exp_f32 v80, v80
  v_exp_f32 v81, v81
  v_exp_f32 v82, v82
  v_smfmac_f32_32x32x32_bf16 v[128:143], v[36:39], v[104:111], v9
  v_exp_f32 v83, v83
  v_exp_f32 v84, v84
  v_exp_f32 v85, v85
  v_mfma_f32_32x32x16_bf16 v[96:111], v[28:31], v[20:23], v[64:79]
  v_exp_f32 v86, v86
  v_exp_f32 v87, v87
  v_exp_f32 v88, v88
  v_exp_f32 v89, v89
  v_exp_f32 v90, v90
  v_smfmac_f32_32x32x32_bf16 v[112:127], v[40:43], v[80:87], v9
  s_mov_b64 exec, s[44:45]
  ds_read_b128 v[32:35], v7 offset:22528
  ds_read_b128 v[36:39], v7 offset:23040
  s_mov_b64 exec, -1
  ds_read_b128 v[28:31], v6 offset:23552
  v_exp_f32 v91, v91
  v_exp_f32 v92, v92
  v_exp_f32 v93, v93
  v_exp_f32 v94, v94
  v_exp_f32 v95, v95
  v_exp_f32 v96, v96
  v_exp_f32 v97, v97
  v_exp_f32 v98, v98
  v_smfmac_f32_32x32x32_bf16 v[112:127], v[44:47], v[88:95], v9
  v_exp_f32 v99, v99
  v_exp_f32 v100, v100
  v_exp_f32 v101, v101
  v_mfma_f32_32x32x16_bf16 v[80:95], v[24:27], v[16:19], v[48:63]
  v_exp_f32 v102, v102
  v_exp_f32 v103, v103
  v_exp_f32 v104, v104
  v_exp_f32 v105, v105
  v_exp_f32 v106, v106
  v_smfmac_f32_32x32x32_bf16 v[128:143], v[40:43], v[96:103], v9
  s_waitcnt lgkmcnt(0)
  v_exp_f32 v107, v107
  v_exp_f32 v108, v108
  v_exp_f32 v109, v109
  v_exp_f32 v110, v110
  v_exp_f32 v111, v111
  v_exp_f32 v80, v80
  v_exp_f32 v81, v81
  v_exp_f32 v82, v82
  v_smfmac_f32_32x32x32_bf16 v[128:143], v[44:47], v[104:111], v9
  v_exp_f32 v83, v83
  v_exp_f32 v84, v84
  v_exp_f32 v85, v85
  v_mfma_f32_32x32x16_bf16 v[96:111], v[24:27], v[20:23], v[64:79]
  v_exp_f32 v86, v86
  v_exp_f32 v87, v87
  v_exp_f32 v88, v88
  v_exp_f32 v89, v89
  v_exp_f32 v90, v90
  v_smfmac_f32_32x32x32_bf16 v[112:127], v[32:35], v[80:87], v9
  s_waitcnt vmcnt(4)
  s_barrier
  s_add_u32 m0, s58, 8192
  s_add_u32 s48, s56, 262144
  buffer_load_dwordx4 v152, s[4:7], s48 offen lds
  s_add_u32 m0, s58, 9216
  s_add_u32 s48, s56, 270336
  buffer_load_dwordx4 v152, s[4:7], s48 offen lds
  s_add_u32 m0, s58, 10240
  s_add_u32 s48, s56, 278528
  buffer_load_dwordx4 v152, s[4:7], s48 offen lds
  s_add_u32 m0, s58, 11264
  s_add_u32 s48, s56, 286720
  buffer_load_dwordx4 v152, s[4:7], s48 offen lds
  s_mov_b64 exec, s[44:45]
  ds_read_b128 v[40:43], v7 offset:23552
  ds_read_b128 v[44:47], v7 offset:24064
  s_mov_b64 exec, -1
  ds_read_b128 v[24:27], v6 offset:24576
  v_exp_f32 v91, v91
  v_exp_f32 v92, v92
  v_exp_f32 v93, v93
  v_exp_f32 v94, v94
  v_exp_f32 v95, v95
  v_exp_f32 v96, v96
  v_exp_f32 v97, v97
  v_exp_f32 v98, v98
  v_smfmac_f32_32x32x32_bf16 v[112:127], v[36:39], v[88:95], v9
  v_exp_f32 v99, v99
  v_exp_f32 v100, v100
  v_exp_f32 v101, v101
  v_mfma_f32_32x32x16_bf16 v[80:95], v[28:31], v[16:19], v[48:63]
  v_exp_f32 v102, v102
  v_exp_f32 v103, v103
  v_exp_f32 v104, v104
  v_exp_f32 v105, v105
  v_exp_f32 v106, v106
  v_smfmac_f32_32x32x32_bf16 v[128:143], v[32:35], v[96:103], v9
  s_waitcnt lgkmcnt(0)
  v_exp_f32 v107, v107
  v_exp_f32 v108, v108
  v_exp_f32 v109, v109
  v_exp_f32 v110, v110
  v_exp_f32 v111, v111
  v_exp_f32 v80, v80
  v_exp_f32 v81, v81
  v_exp_f32 v82, v82
  v_smfmac_f32_32x32x32_bf16 v[128:143], v[36:39], v[104:111], v9
  v_exp_f32 v83, v83
  v_exp_f32 v84, v84
  v_exp_f32 v85, v85
  v_mfma_f32_32x32x16_bf16 v[96:111], v[28:31], v[20:23], v[64:79]
  v_exp_f32 v86, v86
  v_exp_f32 v87, v87
  v_exp_f32 v88, v88
  v_exp_f32 v89, v89
  v_exp_f32 v90, v90
  v_smfmac_f32_32x32x32_bf16 v[112:127], v[40:43], v[80:87], v9
  s_mov_b64 exec, s[44:45]
  ds_read_b128 v[32:35], v7 offset:24576
  ds_read_b128 v[36:39], v7 offset:25088
  s_mov_b64 exec, -1
  ds_read_b128 v[28:31], v6 offset:25600
  v_exp_f32 v91, v91
  v_exp_f32 v92, v92
  v_exp_f32 v93, v93
  v_exp_f32 v94, v94
  v_exp_f32 v95, v95
  v_exp_f32 v96, v96
  v_exp_f32 v97, v97
  v_exp_f32 v98, v98
  v_smfmac_f32_32x32x32_bf16 v[112:127], v[44:47], v[88:95], v9
  v_exp_f32 v99, v99
  v_exp_f32 v100, v100
  v_exp_f32 v101, v101
  v_mfma_f32_32x32x16_bf16 v[80:95], v[24:27], v[16:19], v[48:63]
  v_exp_f32 v102, v102
  v_exp_f32 v103, v103
  v_exp_f32 v104, v104
  v_exp_f32 v105, v105
  v_exp_f32 v106, v106
  v_smfmac_f32_32x32x32_bf16 v[128:143], v[40:43], v[96:103], v9
  s_waitcnt lgkmcnt(0)
  v_exp_f32 v107, v107
  v_exp_f32 v108, v108
  v_exp_f32 v109, v109
  v_exp_f32 v110, v110
  v_exp_f32 v111, v111
  v_exp_f32 v80, v80
  v_exp_f32 v81, v81
  v_exp_f32 v82, v82
  v_smfmac_f32_32x32x32_bf16 v[128:143], v[44:47], v[104:111], v9
  v_exp_f32 v83, v83
  v_exp_f32 v84, v84
  v_exp_f32 v85, v85
  v_mfma_f32_32x32x16_bf16 v[96:111], v[24:27], v[20:23], v[64:79]
  v_exp_f32 v86, v86
  v_exp_f32 v87, v87
  v_exp_f32 v88, v88
  v_exp_f32 v89, v89
  v_exp_f32 v90, v90
  v_smfmac_f32_32x32x32_bf16 v[112:127], v[32:35], v[80:87], v9
  s_mov_b64 exec, s[44:45]
  ds_read_b128 v[40:43], v7 offset:25600
  ds_read_b128 v[44:47], v7 offset:26112
  s_mov_b64 exec, -1
  ds_read_b128 v[24:27], v6 offset:26624
  v_exp_f32 v91, v91
  v_exp_f32 v92, v92
  v_exp_f32 v93, v93
  v_exp_f32 v94, v94
  v_exp_f32 v95, v95
  v_exp_f32 v96, v96
  v_exp_f32 v97, v97
  v_exp_f32 v98, v98
  v_smfmac_f32_32x32x32_bf16 v[112:127], v[36:39], v[88:95], v9
  v_exp_f32 v99, v99
  v_exp_f32 v100, v100
  v_exp_f32 v101, v101
  v_mfma_f32_32x32x16_bf16 v[80:95], v[28:31], v[16:19], v[48:63]
  v_exp_f32 v102, v102
  v_exp_f32 v103, v103
  v_exp_f32 v104, v104
  v_exp_f32 v105, v105
  v_exp_f32 v106, v106
  v_smfmac_f32_32x32x32_bf16 v[128:143], v[32:35], v[96:103], v9
  s_waitcnt lgkmcnt(0)
  v_exp_f32 v107, v107
  v_exp_f32 v108, v108
  v_exp_f32 v109, v109
  v_exp_f32 v110, v110
  v_exp_f32 v111, v111
  v_exp_f32 v80, v80
  v_exp_f32 v81, v81
  v_exp_f32 v82, v82
  v_smfmac_f32_32x32x32_bf16 v[128:143], v[36:39], v[104:111], v9
  v_exp_f32 v83, v83
  v_exp_f32 v84, v84
  v_exp_f32 v85, v85
  v_mfma_f32_32x32x16_bf16 v[96:111], v[28:31], v[20:23], v[64:79]
  v_exp_f32 v86, v86
  v_exp_f32 v87, v87
  v_exp_f32 v88, v88
  v_exp_f32 v89, v89
  v_exp_f32 v90, v90
  v_smfmac_f32_32x32x32_bf16 v[112:127], v[40:43], v[80:87], v9
  s_mov_b64 exec, s[44:45]
  ds_read_b128 v[32:35], v7 offset:26624
  ds_read_b128 v[36:39], v7 offset:27136
  s_mov_b64 exec, -1
  ds_read_b128 v[28:31], v6 offset:27648
  v_exp_f32 v91, v91
  v_exp_f32 v92, v92
  v_exp_f32 v93, v93
  v_exp_f32 v94, v94
  v_exp_f32 v95, v95
  v_exp_f32 v96, v96
  v_exp_f32 v97, v97
  v_exp_f32 v98, v98
  v_smfmac_f32_32x32x32_bf16 v[112:127], v[44:47], v[88:95], v9
  v_exp_f32 v99, v99
  v_exp_f32 v100, v100
  v_exp_f32 v101, v101
  v_mfma_f32_32x32x16_bf16 v[80:95], v[24:27], v[16:19], v[48:63]
  v_exp_f32 v102, v102
  v_exp_f32 v103, v103
  v_exp_f32 v104, v104
  v_exp_f32 v105, v105
  v_exp_f32 v106, v106
  v_smfmac_f32_32x32x32_bf16 v[128:143], v[40:43], v[96:103], v9
  s_waitcnt lgkmcnt(0)
  v_exp_f32 v107, v107
  v_exp_f32 v108, v108
  v_exp_f32 v109, v109
  v_exp_f32 v110, v110
  v_exp_f32 v111, v111
  v_exp_f32 v80, v80
  v_exp_f32 v81, v81
  v_exp_f32 v82, v82
  v_smfmac_f32_32x32x32_bf16 v[128:143], v[44:47], v[104:111], v9
  v_exp_f32 v83, v83
  v_exp_f32 v84, v84
  v_exp_f32 v85, v85
  v_mfma_f32_32x32x16_bf16 v[96:111], v[24:27], v[20:23], v[64:79]
  v_exp_f32 v86, v86
  v_exp_f32 v87, v87
  v_exp_f32 v88, v88
  v_exp_f32 v89, v89
  v_exp_f32 v90, v90
  v_smfmac_f32_32x32x32_bf16 v[112:127], v[32:35], v[80:87], v9
  s_barrier
  s_add_u32 m0, s58, 16384
  s_add_u32 s48, s56, 393216
  buffer_load_dwordx4 v152, s[4:7], s48 offen lds
  s_add_u32 m0, s58, 17408
  s_add_u32 s48, s56, 401408
  buffer_load_dwordx4 v152, s[4:7], s48 offen lds
  s_add_u32 m0, s58, 18432
  s_add_u32 s48, s56, 409600
  buffer_load_dwordx4 v152, s[4:7], s48 offen lds
  s_add_u32 m0, s58, 19456
  s_add_u32 s48, s56, 417792
  buffer_load_dwordx4 v152, s[4:7], s48 offen lds
  s_mov_b64 exec, s[44:45]
  ds_read_b128 v[40:43], v7 offset:27648
  ds_read_b128 v[44:47], v7 offset:28160
  s_mov_b64 exec, -1
  ds_read_b128 v[24:27], v6 offset:28672
  v_exp_f32 v91, v91
  v_exp_f32 v92, v92
  v_exp_f32 v93, v93
  v_exp_f32 v94, v94
  v_exp_f32 v95, v95
  v_exp_f32 v96, v96
  v_exp_f32 v97, v97
  v_exp_f32 v98, v98
  v_smfmac_f32_32x32x32_bf16 v[112:127], v[36:39], v[88:95], v9
  v_exp_f32 v99, v99
  v_exp_f32 v100, v100
  v_exp_f32 v101, v101
  v_mfma_f32_32x32x16_bf16 v[80:95], v[28:31], v[16:19], v[48:63]
  v_exp_f32 v102, v102
  v_exp_f32 v103, v103
  v_exp_f32 v104, v104
  v_exp_f32 v105, v105
  v_exp_f32 v106, v106
  v_smfmac_f32_32x32x32_bf16 v[128:143], v[32:35], v[96:103], v9
  s_waitcnt lgkmcnt(0)
  v_exp_f32 v107, v107
  v_exp_f32 v108, v108
  v_exp_f32 v109, v109
  v_exp_f32 v110, v110
  v_exp_f32 v111, v111
  v_exp_f32 v80, v80
  v_exp_f32 v81, v81
  v_exp_f32 v82, v82
  v_smfmac_f32_32x32x32_bf16 v[128:143], v[36:39], v[104:111], v9
  v_exp_f32 v83, v83
  v_exp_f32 v84, v84
  v_exp_f32 v85, v85
  v_mfma_f32_32x32x16_bf16 v[96:111], v[28:31], v[20:23], v[64:79]
  v_exp_f32 v86, v86
  v_exp_f32 v87, v87
  v_exp_f32 v88, v88
  v_exp_f32 v89, v89
  v_exp_f32 v90, v90
  v_smfmac_f32_32x32x32_bf16 v[112:127], v[40:43], v[80:87], v9
  s_mov_b64 exec, s[44:45]
  ds_read_b128 v[32:35], v7 offset:28672
  ds_read_b128 v[36:39], v7 offset:29184
  s_mov_b64 exec, -1
  ds_read_b128 v[28:31], v6 offset:29696
  v_exp_f32 v91, v91
  v_exp_f32 v92, v92
  v_exp_f32 v93, v93
  v_exp_f32 v94, v94
  v_exp_f32 v95, v95
  v_exp_f32 v96, v96
  v_exp_f32 v97, v97
  v_exp_f32 v98, v98
  v_smfmac_f32_32x32x32_bf16 v[112:127], v[44:47], v[88:95], v9
  v_exp_f32 v99, v99
  v_exp_f32 v100, v100
  v_exp_f32 v101, v101
  v_mfma_f32_32x32x16_bf16 v[80:95], v[24:27], v[16:19], v[48:63]
  v_exp_f32 v102, v102
  v_exp_f32 v103, v103
  v_exp_f32 v104, v104
  v_exp_f32 v105, v105
  v_exp_f32 v106, v106
  v_smfmac_f32_32x32x32_bf16 v[128:143], v[40:43], v[96:103], v9
  s_waitcnt lgkmcnt(0)
  v_exp_f32 v107, v107
  v_exp_f32 v108, v108
  v_exp_f32 v109, v109
  v_exp_f32 v110, v110
  v_exp_f32 v111, v111
  v_exp_f32 v80, v80
  v_exp_f32 v81, v81
  v_exp_f32 v82, v82
  v_smfmac_f32_32x32x32_bf16 v[128:143], v[44:47], v[104:111], v9
  v_exp_f32 v83, v83
  v_exp_f32 v84, v84
  v_exp_f32 v85, v85
  v_mfma_f32_32x32x16_bf16 v[96:111], v[24:27], v[20:23], v[64:79]
  v_exp_f32 v86, v86
  v_exp_f32 v87, v87
  v_exp_f32 v88, v88
  v_exp_f32 v89, v89
  v_exp_f32 v90, v90
  v_smfmac_f32_32x32x32_bf16 v[112:127], v[32:35], v[80:87], v9
  s_mov_b64 exec, s[44:45]
  ds_read_b128 v[40:43], v7 offset:29696
  ds_read_b128 v[44:47], v7 offset:30208
  s_mov_b64 exec, -1
  ds_read_b128 v[24:27], v6 offset:30720
  v_exp_f32 v91, v91
  v_exp_f32 v92, v92
  v_exp_f32 v93, v93
  v_exp_f32 v94, v94
  v_exp_f32 v95, v95
  v_exp_f32 v96, v96
  v_exp_f32 v97, v97
  v_exp_f32 v98, v98
  v_smfmac_f32_32x32x32_bf16 v[112:127], v[36:39], v[88:95], v9
  v_exp_f32 v99, v99
  v_exp_f32 v100, v100
  v_exp_f32 v101, v101
  v_mfma_f32_32x32x16_bf16 v[80:95], v[28:31], v[16:19], v[48:63]
  v_exp_f32 v102, v102
  v_exp_f32 v103, v103
  v_exp_f32 v104, v104
  v_exp_f32 v105, v105
  v_exp_f32 v106, v106
  v_smfmac_f32_32x32x32_bf16 v[128:143], v[32:35], v[96:103], v9
  s_waitcnt lgkmcnt(0)
  v_exp_f32 v107, v107
  v_exp_f32 v108, v108
  v_exp_f32 v109, v109
  v_exp_f32 v110, v110
  v_exp_f32 v111, v111
  v_exp_f32 v80, v80
  v_exp_f32 v81, v81
  v_exp_f32 v82, v82
  v_smfmac_f32_32x32x32_bf16 v[128:143], v[36:39], v[104:111], v9
  v_exp_f32 v83, v83
  v_exp_f32 v84, v84
  v_exp_f32 v85, v85
  v_mfma_f32_32x32x16_bf16 v[96:111], v[28:31], v[20:23], v[64:79]
  v_exp_f32 v86, v86
  v_exp_f32 v87, v87
  v_exp_f32 v88, v88
  v_exp_f32 v89, v89
  v_exp_f32 v90, v90
  v_smfmac_f32_32x32x32_bf16 v[112:127], v[40:43], v[80:87], v9
  s_mov_b64 exec, s[44:45]
  ds_read_b128 v[32:35], v7 offset:30720
  ds_read_b128 v[36:39], v7 offset:31232
  s_mov_b64 exec, -1
  ds_read_b128 v[28:31], v6 offset:31744
  v_exp_f32 v91, v91
  v_exp_f32 v92, v92
  v_exp_f32 v93, v93
  v_exp_f32 v94, v94
  v_exp_f32 v95, v95
  v_exp_f32 v96, v96
  v_exp_f32 v97, v97
  v_exp_f32 v98, v98
  v_smfmac_f32_32x32x32_bf16 v[112:127], v[44:47], v[88:95], v9
  v_exp_f32 v99, v99
  v_exp_f32 v100, v100
  v_exp_f32 v101, v101
  v_mfma_f32_32x32x16_bf16 v[80:95], v[24:27], v[16:19], v[48:63]
  v_exp_f32 v102, v102
  v_exp_f32 v103, v103
  v_exp_f32 v104, v104
  v_exp_f32 v105, v105
  v_exp_f32 v106, v106
  v_smfmac_f32_32x32x32_bf16 v[128:143], v[40:43], v[96:103], v9
  s_waitcnt lgkmcnt(0)
  v_exp_f32 v107, v107
  v_exp_f32 v108, v108
  v_exp_f32 v109, v109
  v_exp_f32 v110, v110
  v_exp_f32 v111, v111
  v_exp_f32 v80, v80
  v_exp_f32 v81, v81
  v_exp_f32 v82, v82
  v_smfmac_f32_32x32x32_bf16 v[128:143], v[44:47], v[104:111], v9
  v_exp_f32 v83, v83
  v_exp_f32 v84, v84
  v_exp_f32 v85, v85
  v_mfma_f32_32x32x16_bf16 v[96:111], v[24:27], v[20:23], v[64:79]
  v_exp_f32 v86, v86
  v_exp_f32 v87, v87
  v_exp_f32 v88, v88
  v_exp_f32 v89, v89
  v_exp_f32 v90, v90
  v_smfmac_f32_32x32x32_bf16 v[112:127], v[32:35], v[80:87], v9
  s_mov_b64 exec, s[44:45]
  ds_read_b128 v[40:43], v7 offset:31744
  ds_read_b128 v[44:47], v7 offset:32256
  s_mov_b64 exec, -1
  v_exp_f32 v91, v91
  v_exp_f32 v92, v92
  v_exp_f32 v93, v93
  v_exp_f32 v94, v94
  v_exp_f32 v95, v95
  v_exp_f32 v96, v96
  v_exp_f32 v97, v97
  v_exp_f32 v98, v98
  v_smfmac_f32_32x32x32_bf16 v[112:127], v[36:39], v[88:95], v9
  v_exp_f32 v99, v99
  v_exp_f32 v100, v100
  v_exp_f32 v101, v101
  v_mfma_f32_32x32x16_bf16 v[80:95], v[28:31], v[16:19], v[48:63]
  v_exp_f32 v102, v102
  v_exp_f32 v103, v103
  v_exp_f32 v104, v104
  v_exp_f32 v105, v105
  v_exp_f32 v106, v106
  v_smfmac_f32_32x32x32_bf16 v[128:143], v[32:35], v[96:103], v9
  s_waitcnt lgkmcnt(0)
  v_exp_f32 v107, v107
  v_exp_f32 v108, v108
  v_exp_f32 v109, v109
  v_exp_f32 v110, v110
  v_exp_f32 v111, v111
  v_exp_f32 v80, v80
  v_exp_f32 v81, v81
  v_exp_f32 v82, v82
  v_smfmac_f32_32x32x32_bf16 v[128:143], v[36:39], v[104:111], v9
  v_exp_f32 v83, v83
  v_exp_f32 v84, v84
  v_exp_f32 v85, v85
  v_mfma_f32_32x32x16_bf16 v[96:111], v[28:31], v[20:23], v[64:79]
  v_exp_f32 v86, v86
  v_exp_f32 v87, v87
  v_exp_f32 v88, v88
  v_exp_f32 v89, v89
  v_exp_f32 v90, v90
  v_smfmac_f32_32x32x32_bf16 v[112:127], v[40:43], v[80:87], v9
  s_nop 0
  v_exp_f32 v91, v91
  v_exp_f32 v92, v92
  v_exp_f32 v93, v93
  v_exp_f32 v94, v94
  v_exp_f32 v95, v95
  v_exp_f32 v96, v96
  v_exp_f32 v97, v97
  v_exp_f32 v98, v98
  v_smfmac_f32_32x32x32_bf16 v[112:127], v[44:47], v[88:95], v9
  v_exp_f32 v99, v99
  v_exp_f32 v100, v100
  v_exp_f32 v101, v101
  v_exp_f32 v102, v102
  v_exp_f32 v103, v103
  v_exp_f32 v104, v104
  v_exp_f32 v105, v105
  v_exp_f32 v106, v106
  v_smfmac_f32_32x32x32_bf16 v[128:143], v[40:43], v[96:103], v9
  s_waitcnt lgkmcnt(0)
  v_exp_f32 v107, v107
  v_exp_f32 v108, v108
  v_exp_f32 v109, v109
  v_exp_f32 v110, v110
  v_exp_f32 v111, v111
  s_nop 2
  v_smfmac_f32_32x32x32_bf16 v[128:143], v[44:47], v[104:111], v9
  s_setprio 0
  s_nop 15
  s_nop 3
  v_mov_b32 v2, v120
  v_mov_b32 v3, v120
  s_nop 1
  v_permlane32_swap_b32 v2, v3
  s_nop 1
  v_mov_b32 v4, v136
  v_mov_b32 v3, v136
  s_nop 1
  v_permlane32_swap_b32 v4, v3
  s_nop 1
  s_mov_b32 s39, 0x5d800000
  v_mov_b32 v3, s39
  v_cmp_nle_f32 vcc, v2, v3
  s_nop 1
  s_mov_b64 s[52:53], vcc
  v_cmp_nle_f32 vcc, v4, v3
  s_nop 1
  s_or_b64 s[52:53], s[52:53], vcc
  s_mov_b32 s39, 0x21800000
  v_mov_b32 v3, s39
  v_cmp_nge_f32 vcc, v2, v3
  s_nop 1
  s_or_b64 s[52:53], s[52:53], vcc
  v_cmp_nge_f32 vcc, v4, v3
  s_nop 1
  s_or_b64 s[52:53], s[52:53], vcc
  s_cmp_eq_u64 s[52:53], 0
  s_cbranch_scc1 gated_mix__mha_block__mha_block__prompt_kernel_fin
  v_mov_b32 v2, 0xff800000
  v_mov_b32 v4, 0xff800000
  s_mov_b32 s36, 0
  s_waitcnt vmcnt(0)
gated_mix__mha_block__mha_block__prompt_kernel_maxloop:
  s_add_u32 s48, s46, s36
  buffer_load_dwordx4 v[24:27], v5, s[12:15], s48 offen sc1
  s_add_u32 s36, s36, 2048
  s_waitcnt vmcnt(0)
  v_mfma_f32_32x32x16_bf16 v[80:95], v[24:27], v[16:19], 0
  v_mfma_f32_32x32x16_bf16 v[96:111], v[24:27], v[20:23], 0
  s_nop 15
  s_nop 3
  v_max3_f32 v2, v2, v80, v81
  v_max3_f32 v2, v2, v82, v83
  v_max3_f32 v2, v2, v84, v85
  v_max3_f32 v2, v2, v86, v87
  v_max3_f32 v2, v2, v88, v89
  v_max3_f32 v2, v2, v90, v91
  v_max3_f32 v2, v2, v92, v93
  v_max3_f32 v2, v2, v94, v95
  v_max3_f32 v4, v4, v96, v97
  v_max3_f32 v4, v4, v98, v99
  v_max3_f32 v4, v4, v100, v101
  v_max3_f32 v4, v4, v102, v103
  v_max3_f32 v4, v4, v104, v105
  v_max3_f32 v4, v4, v106, v107
  v_max3_f32 v4, v4, v108, v109
  v_max3_f32 v4, v4, v110, v111
  s_cmp_lt_u32 s36, 131072
  s_cbranch_scc1 gated_mix__mha_block__mha_block__prompt_kernel_maxloop
  v_mov_b32 v3, v2
  s_nop 1
  v_permlane32_swap_b32 v2, v3
  s_nop 1
  v_max_f32 v2, v2, v3
  v_sub_f32 v2, 0, v2
  v_mov_b32 v48, v2
  v_mov_b32 v49, v2
  v_mov_b32 v50, v2
  v_mov_b32 v51, v2
  v_mov_b32 v52, v2
  v_mov_b32 v53, v2
  v_mov_b32 v54, v2
  v_mov_b32 v55, v2
  v_mov_b32 v56, v2
  v_mov_b32 v57, v2
  v_mov_b32 v58, v2
  v_mov_b32 v59, v2
  v_mov_b32 v60, v2
  v_mov_b32 v61, v2
  v_mov_b32 v62, v2
  v_mov_b32 v63, v2
  v_mov_b32 v3, v4
  s_nop 1
  v_permlane32_swap_b32 v4, v3
  s_nop 1
  v_max_f32 v4, v4, v3
  v_sub_f32 v4, 0, v4
  v_mov_b32 v64, v4
  v_mov_b32 v65, v4
  v_mov_b32 v66, v4
  v_mov_b32 v67, v4
  v_mov_b32 v68, v4
  v_mov_b32 v69, v4
  v_mov_b32 v70, v4
  v_mov_b32 v71, v4
  v_mov_b32 v72, v4
  v_mov_b32 v73, v4
  v_mov_b32 v74, v4
  v_mov_b32 v75, v4
  v_mov_b32 v76, v4
  v_mov_b32 v77, v4
  v_mov_b32 v78, v4
  v_mov_b32 v79, v4
  v_mov_b32 v112, 0
  v_mov_b32 v113, 0
  v_mov_b32 v114, 0
  v_mov_b32 v115, 0
  v_mov_b32 v116, 0
  v_mov_b32 v117, 0
  v_mov_b32 v118, 0
  v_mov_b32 v119, 0
  v_mov_b32 v120, 0
  v_mov_b32 v121, 0
  v_mov_b32 v122, 0
  v_mov_b32 v123, 0
  v_mov_b32 v124, 0
  v_mov_b32 v125, 0
  v_mov_b32 v126, 0
  v_mov_b32 v127, 0
  v_mov_b32 v128, 0
  v_mov_b32 v129, 0
  v_mov_b32 v130, 0
  v_mov_b32 v131, 0
  v_mov_b32 v132, 0
  v_mov_b32 v133, 0
  v_mov_b32 v134, 0
  v_mov_b32 v135, 0
  v_mov_b32 v136, 0
  v_mov_b32 v137, 0
  v_mov_b32 v138, 0
  v_mov_b32 v139, 0
  v_mov_b32 v140, 0
  v_mov_b32 v141, 0
  v_mov_b32 v142, 0
  v_mov_b32 v143, 0
  s_mov_b32 s36, 0
gated_mix__mha_block__mha_block__prompt_kernel_slowloop:
  s_add_u32 s48, s46, s36
  buffer_load_dwordx4 v[24:27], v5, s[12:15], s48 offen sc1
  s_mov_b64 exec, s[44:45]
  buffer_load_dwordx4 v[32:35], v8, s[12:15], s48 offen sc1
  buffer_load_dwordx4 v[36:39], v8, s[12:15], s48 offen offset:512 sc1
  s_mov_b64 exec, -1
  s_add_u32 s36, s36, 2048
  s_waitcnt vmcnt(0)
  v_mfma_f32_32x32x16_bf16 v[80:95], v[24:27], v[16:19], v[48:63]
  v_mfma_f32_32x32x16_bf16 v[96:111], v[24:27], v[20:23], v[64:79]
  s_nop 15
  s_nop 3
  v_exp_f32 v80, v80
  v_exp_f32 v81, v81
  v_exp_f32 v82, v82
  v_exp_f32 v83, v83
  v_exp_f32 v84, v84
  v_exp_f32 v85, v85
  v_exp_f32 v86, v86
  v_exp_f32 v87, v87
  v_exp_f32 v88, v88
  v_exp_f32 v89, v89
  v_exp_f32 v90, v90
  v_exp_f32 v91, v91
  v_exp_f32 v92, v92
  v_exp_f32 v93, v93
  v_exp_f32 v94, v94
  v_exp_f32 v95, v95
  v_exp_f32 v96, v96
  v_exp_f32 v97, v97
  v_exp_f32 v98, v98
  v_exp_f32 v99, v99
  v_exp_f32 v100, v100
  v_exp_f32 v101, v101
  v_exp_f32 v102, v102
  v_exp_f32 v103, v103
  v_exp_f32 v104, v104
  v_exp_f32 v105, v105
  v_exp_f32 v106, v106
  v_exp_f32 v107, v107
  v_exp_f32 v108, v108
  v_exp_f32 v109, v109
  v_exp_f32 v110, v110
  v_exp_f32 v111, v111
  s_nop 1
  v_smfmac_f32_32x32x32_bf16 v[112:127], v[32:35], v[80:87], v9
  v_smfmac_f32_32x32x32_bf16 v[112:127], v[36:39], v[88:95], v9
  v_smfmac_f32_32x32x32_bf16 v[128:143], v[32:35], v[96:103], v9
  v_smfmac_f32_32x32x32_bf16 v[128:143], v[36:39], v[104:111], v9
  s_cmp_lt_u32 s36, 131072
  s_cbranch_scc1 gated_mix__mha_block__mha_block__prompt_kernel_slowloop
  s_nop 15
  s_nop 3
  v_mov_b32 v2, v120
  v_mov_b32 v3, v120
  s_nop 1
  v_permlane32_swap_b32 v2, v3
  s_nop 1
  v_mov_b32 v4, v136
  v_mov_b32 v3, v136
  s_nop 1
  v_permlane32_swap_b32 v4, v3
  s_nop 1
gated_mix__mha_block__mha_block__prompt_kernel_fin:
  s_lshr_b32 s48, s54, 2
  s_lshl_b32 s48, s48, 12
  s_add_u32 s48, s48, 22183936
  v_and_b32 v250, 31, v1
  v_lshlrev_b32 v250, 7, v250
  buffer_load_dword v251, v250, s[12:15], s48 offen sc1
  s_lshl_b32 s36, s21, 6
  s_add_u32 s36, s36, s51
  s_lshl_b32 s36, s36, 5
  s_lshl_b32 s37, s22, 1
  s_add_u32 s36, s36, s37
  s_add_u32 s36, s36, s49
  s_lshl_b32 s36, s36, 10
  s_add_u32 s36, s36, 16777216
  v_rcp_f32 v2, v2
  v_rcp_f32 v4, v4
  s_nop 0
  v_mul_f32 v112, v112, v2
  v_mul_f32 v113, v113, v2
  v_mul_f32 v114, v114, v2
  v_mul_f32 v115, v115, v2
  v_mul_f32 v116, v116, v2
  v_mul_f32 v117, v117, v2
  v_mul_f32 v118, v118, v2
  v_mul_f32 v119, v119, v2
  v_cvt_pk_bf16_f32 v144, v112, v113
  v_cvt_pk_bf16_f32 v145, v114, v115
  v_cvt_pk_bf16_f32 v146, v116, v117
  v_cvt_pk_bf16_f32 v147, v118, v119
  s_add_u32 s37, s36, 0
  buffer_store_dwordx4 v[144:147], v5, s[12:15], s37 offen sc1
  v_mul_f32 v128, v128, v4
  v_mul_f32 v129, v129, v4
  v_mul_f32 v130, v130, v4
  v_mul_f32 v131, v131, v4
  v_mul_f32 v132, v132, v4
  v_mul_f32 v133, v133, v4
  v_mul_f32 v134, v134, v4
  v_mul_f32 v135, v135, v4
  v_cvt_pk_bf16_f32 v148, v128, v129
  v_cvt_pk_bf16_f32 v149, v130, v131
  v_cvt_pk_bf16_f32 v150, v132, v133
  v_cvt_pk_bf16_f32 v151, v134, v135
  s_add_u32 s37, s36, 32768
  buffer_store_dwordx4 v[148:151], v5, s[12:15], s37 offen sc1
  s_waitcnt vmcnt(0)
  s_barrier
  s_cmp_ge_u32 s20, 4
  s_cbranch_scc1 gated_mix__mha_block__mha_block__prompt_kernel_done
  v_lshlrev_b32 v5, 4, v1
  s_cmp_lg_u32 s20, 0
  s_cbranch_scc1 gated_mix__mha_block__mha_block__prompt_kernel_p3_setup
  s_lshl_b32 s36, s23, 5
  s_add_u32 s36, s36, s95
  s_lshl_b32 s36, s36, 7
  s_add_u32 s36, s36, 22183936
  v_mov_b32 v2, s94
  v_mov_b32 v3, 0
  s_mov_b64 exec, 1
  buffer_store_dword v2, v3, s[12:15], s36 offen sc1
  s_mov_b64 exec, -1
gated_mix__mha_block__mha_block__prompt_kernel_p3_setup:
  s_and_b32 s42, s20, 1
  s_lshr_b32 s43, s20, 1
  s_lshr_b32 s36, s54, 2
  s_lshl_b32 s36, s36, 12
  s_add_u32 s39, s36, 22183936
  v_and_b32 v3, 31, v1
  v_lshlrev_b32 v7, 7, v3
  s_lshl_b32 s36, s43, 6
  s_lshl_b32 s37, s54, 1
  s_add_u32 s36, s36, s37
  s_add_u32 s36, s36, s42
  s_lshl_b32 s36, s36, 15
  s_add_u32 s45, s36, 16777216
  v_lshrrev_b32 v2, 5, v1
  v_lshlrev_b32 v2, 2, v2
  v_bfe_u32 v3, v1, 2, 2
  v_add_u32 v2, v2, v3
  v_lshlrev_b32 v2, 7, v2
  v_bfe_u32 v3, v1, 4, 1
  v_lshl_add_u32 v2, v3, 5, v2
  v_and_b32 v3, 3, v1
  v_lshlrev_b32 v3, 3, v3
  v_add_u32 v2, v2, v3
  v_bfe_u32 v3, v1, 3, 1
  v_lshlrev_b32 v3, 6, v3
  v_xor_b32 v2, v2, v3
  s_lshl_b32 s36, s43, 16
  v_add_u32 v11, s36, v2
  v_xor_b32 v12, 64, v11
  s_lshl_b32 s36, s43, 14
  s_add_u32 s36, s36, 131072
  v_add_u32 v13, s36, v2
  v_xor_b32 v14, 64, v13
  v_and_b32 v2, 31, v1
  v_lshlrev_b32 v8, 2, v2
  v_lshlrev_b32 v9, 10, v2
  v_lshrrev_b32 v3, 5, v1
  v_lshl_add_u32 v9, v3, 4, v9
  s_lshl_b32 s36, s54, 8
  s_lshl_b32 s37, s42, 7
  s_add_u32 s36, s36, s37
  s_add_u32 s47, s36, 20971520
  s_lshl_b32 s36, s54, 16
  s_lshl_b32 s37, s42, 15
  s_add_u32 s36, s36, s37
  s_lshl_b32 s37, s55, 7
  s_add_u32 s48, s36, s37
  s_lshl_b32 s36, s42, 15
  s_add_u32 s36, s36, 24576
  v_add_u32 v10, s36, v5
  s_mov_b32 s8, s90
  s_and_b32 s9, s91, 0xffff
  s_mov_b32 s10, 2097152
  s_mov_b32 s11, 0x20000
  v_mov_b32 v160, 0
  v_mov_b32 v161, 0
  v_mov_b32 v162, 0
  v_mov_b32 v163, 0
  v_mov_b32 v164, 0
  v_mov_b32 v165, 0
  v_mov_b32 v166, 0
  v_mov_b32 v167, 0
  v_mov_b32 v168, 0
  v_mov_b32 v169, 0
  v_mov_b32 v170, 0
  v_mov_b32 v171, 0
  v_mov_b32 v172, 0
  v_mov_b32 v173, 0
  v_mov_b32 v174, 0
  v_mov_b32 v175, 0
  v_mov_b32 v176, 0
  v_mov_b32 v177, 0
  v_mov_b32 v178, 0
  v_mov_b32 v179, 0
  v_mov_b32 v180, 0
  v_mov_b32 v181, 0
  v_mov_b32 v182, 0
  v_mov_b32 v183, 0
  v_mov_b32 v184, 0
  v_mov_b32 v185, 0
  v_mov_b32 v186, 0
  v_mov_b32 v187, 0
  v_mov_b32 v188, 0
  v_mov_b32 v189, 0
  v_mov_b32 v190, 0
  v_mov_b32 v191, 0
  ds_read_b64_tr_b16 v[144:145], v13 offset:0
  ds_read_b64_tr_b16 v[146:147], v13 offset:1024
  ds_read_b64_tr_b16 v[148:149], v14 offset:0
  ds_read_b64_tr_b16 v[150:151], v14 offset:1024
  v_cmp_eq_u32 vcc, s94, v251
  s_lshr_b32 s36, s54, 2
  s_lshl_b32 s37, 1, s95
  s_cmp_eq_u32 s36, s23
  s_cselect_b32 s37, s37, 0
  s_or_b32 s37, s37, vcc_lo
  s_cmp_eq_u32 s37, -1
  s_cbranch_scc1 gated_mix__mha_block__mha_block__prompt_kernel_poll2_ok
  buffer_load_dword v4, v7, s[12:15], s39 offen sc1
gated_mix__mha_block__mha_block__prompt_kernel_poll2:
  s_waitcnt vmcnt(0)
  v_cmp_ne_u32 vcc, s94, v4
  s_nop 1
  s_cmp_eq_u64 vcc, 0
  s_cbranch_scc1 gated_mix__mha_block__mha_block__prompt_kernel_poll2_ok
  s_add_u32 s100, s100, 1
  s_cmp_gt_u32 s100, 200000
  s_cbranch_scc1 gated_mix__mha_block__mha_block__prompt_kernel_poll2_ok
  s_sleep 1
  buffer_load_dword v4, v7, s[12:15], s39 offen sc1
  s_branch gated_mix__mha_block__mha_block__prompt_kernel_poll2
gated_mix__mha_block__mha_block__prompt_kernel_poll2_ok:
  s_add_u32 s46, s45, 0
  buffer_load_dwordx4 v[16:19], v5, s[12:15], s46 offen offset:0 sc1
  buffer_load_dwordx4 v[20:23], v5, s[12:15], s46 offen offset:1024 sc1
  buffer_load_dwordx4 v[24:27], v5, s[12:15], s46 offen offset:2048 sc1
  buffer_load_dwordx4 v[28:31], v5, s[12:15], s46 offen offset:3072 sc1
  s_add_u32 s46, s45, 4096
  buffer_load_dwordx4 v[32:35], v5, s[12:15], s46 offen offset:0 sc1
  buffer_load_dwordx4 v[36:39], v5, s[12:15], s46 offen offset:1024 sc1
  buffer_load_dwordx4 v[40:43], v5, s[12:15], s46 offen offset:2048 sc1
  buffer_load_dwordx4 v[44:47], v5, s[12:15], s46 offen offset:3072 sc1
  s_add_u32 s46, s45, 8192
  buffer_load_dwordx4 v[48:51], v5, s[12:15], s46 offen offset:0 sc1
  buffer_load_dwordx4 v[52:55], v5, s[12:15], s46 offen offset:1024 sc1
  buffer_load_dwordx4 v[56:59], v5, s[12:15], s46 offen offset:2048 sc1
  buffer_load_dwordx4 v[60:63], v5, s[12:15], s46 offen offset:3072 sc1
  s_add_u32 s46, s45, 12288
  buffer_load_dwordx4 v[64:67], v5, s[12:15], s46 offen offset:0 sc1
  buffer_load_dwordx4 v[68:71], v5, s[12:15], s46 offen offset:1024 sc1
  buffer_load_dwordx4 v[72:75], v5, s[12:15], s46 offen offset:2048 sc1
  buffer_load_dwordx4 v[76:79], v5, s[12:15], s46 offen offset:3072 sc1
  s_add_u32 s46, s45, 16384
  buffer_load_dwordx4 v[80:83], v5, s[12:15], s46 offen offset:0 sc1
  buffer_load_dwordx4 v[84:87], v5, s[12:15], s46 offen offset:1024 sc1
  buffer_load_dwordx4 v[88:91], v5, s[12:15], s46 offen offset:2048 sc1
  buffer_load_dwordx4 v[92:95], v5, s[12:15], s46 offen offset:3072 sc1
  s_add_u32 s46, s45, 20480
  buffer_load_dwordx4 v[96:99], v5, s[12:15], s46 offen offset:0 sc1
  buffer_load_dwordx4 v[100:103], v5, s[12:15], s46 offen offset:1024 sc1
  buffer_load_dwordx4 v[104:107], v5, s[12:15], s46 offen offset:2048 sc1
  buffer_load_dwordx4 v[108:111], v5, s[12:15], s46 offen offset:3072 sc1
  s_add_u32 s46, s45, 24576
  buffer_load_dwordx4 v[112:115], v5, s[12:15], s46 offen offset:0 sc1
  buffer_load_dwordx4 v[116:119], v5, s[12:15], s46 offen offset:1024 sc1
  buffer_load_dwordx4 v[120:123], v5, s[12:15], s46 offen offset:2048 sc1
  buffer_load_dwordx4 v[124:127], v5, s[12:15], s46 offen offset:3072 sc1
  s_add_u32 s46, s45, 28672
  buffer_load_dwordx4 v[128:131], v5, s[12:15], s46 offen offset:0 sc1
  buffer_load_dwordx4 v[132:135], v5, s[12:15], s46 offen offset:1024 sc1
  buffer_load_dwordx4 v[136:139], v5, s[12:15], s46 offen offset:2048 sc1
  buffer_load_dwordx4 v[140:143], v5, s[12:15], s46 offen offset:3072 sc1
  buffer_load_dword v6, v8, s[12:15], s47 offen sc1
  s_waitcnt vmcnt(32) lgkmcnt(0)
  v_mfma_f32_32x32x16_bf16 v[160:175], v[144:147], v[16:19], v[160:175]
  ds_read_b64_tr_b16 v[152:153], v13 offset:2048
  ds_read_b64_tr_b16 v[154:155], v13 offset:3072
  ds_read_b64_tr_b16 v[156:157], v14 offset:2048
  ds_read_b64_tr_b16 v[158:159], v14 offset:3072
  v_mfma_f32_32x32x16_bf16 v[176:191], v[148:151], v[16:19], v[176:191]
  s_waitcnt vmcnt(31) lgkmcnt(0)
  v_mfma_f32_32x32x16_bf16 v[160:175], v[152:155], v[20:23], v[160:175]
  ds_read_b64_tr_b16 v[144:145], v13 offset:4096
  ds_read_b64_tr_b16 v[146:147], v13 offset:5120
  ds_read_b64_tr_b16 v[148:149], v14 offset:4096
  ds_read_b64_tr_b16 v[150:151], v14 offset:5120
  v_mfma_f32_32x32x16_bf16 v[176:191], v[156:159], v[20:23], v[176:191]
  s_waitcnt vmcnt(30) lgkmcnt(0)
  v_mfma_f32_32x32x16_bf16 v[160:175], v[144:147], v[24:27], v[160:175]
  ds_read_b64_tr_b16 v[152:153], v13 offset:6144
  ds_read_b64_tr_b16 v[154:155], v13 offset:7168
  ds_read_b64_tr_b16 v[156:157], v14 offset:6144
  ds_read_b64_tr_b16 v[158:159], v14 offset:7168
  v_mfma_f32_32x32x16_bf16 v[176:191], v[148:151], v[24:27], v[176:191]
  s_waitcnt vmcnt(29) lgkmcnt(0)
  v_mfma_f32_32x32x16_bf16 v[160:175], v[152:155], v[28:31], v[160:175]
  ds_read_b64_tr_b16 v[144:145], v13 offset:8192
  ds_read_b64_tr_b16 v[146:147], v13 offset:9216
  ds_read_b64_tr_b16 v[148:149], v14 offset:8192
  ds_read_b64_tr_b16 v[150:151], v14 offset:9216
  v_mfma_f32_32x32x16_bf16 v[176:191], v[156:159], v[28:31], v[176:191]
  s_waitcnt vmcnt(28) lgkmcnt(0)
  v_mfma_f32_32x32x16_bf16 v[160:175], v[144:147], v[32:35], v[160:175]
  ds_read_b64_tr_b16 v[152:153], v13 offset:10240
  ds_read_b64_tr_b16 v[154:155], v13 offset:11264
  ds_read_b64_tr_b16 v[156:157], v14 offset:10240
  ds_read_b64_tr_b16 v[158:159], v14 offset:11264
  v_mfma_f32_32x32x16_bf16 v[176:191], v[148:151], v[32:35], v[176:191]
  s_waitcnt vmcnt(27) lgkmcnt(0)
  v_mfma_f32_32x32x16_bf16 v[160:175], v[152:155], v[36:39], v[160:175]
  ds_read_b64_tr_b16 v[144:145], v13 offset:12288
  ds_read_b64_tr_b16 v[146:147], v13 offset:13312
  ds_read_b64_tr_b16 v[148:149], v14 offset:12288
  ds_read_b64_tr_b16 v[150:151], v14 offset:13312
  v_mfma_f32_32x32x16_bf16 v[176:191], v[156:159], v[36:39], v[176:191]
  s_waitcnt vmcnt(26) lgkmcnt(0)
  v_mfma_f32_32x32x16_bf16 v[160:175], v[144:147], v[40:43], v[160:175]
  ds_read_b64_tr_b16 v[152:153], v13 offset:14336
  ds_read_b64_tr_b16 v[154:155], v13 offset:15360
  ds_read_b64_tr_b16 v[156:157], v14 offset:14336
  ds_read_b64_tr_b16 v[158:159], v14 offset:15360
  v_mfma_f32_32x32x16_bf16 v[176:191], v[148:151], v[40:43], v[176:191]
  s_waitcnt vmcnt(25) lgkmcnt(0)
  v_mfma_f32_32x32x16_bf16 v[160:175], v[152:155], v[44:47], v[160:175]
  ds_read_b64_tr_b16 v[144:145], v11 offset:0
  ds_read_b64_tr_b16 v[146:147], v11 offset:1024
  ds_read_b64_tr_b16 v[148:149], v12 offset:0
  ds_read_b64_tr_b16 v[150:151], v12 offset:1024
  v_mfma_f32_32x32x16_bf16 v[176:191], v[156:159], v[44:47], v[176:191]
  s_waitcnt vmcnt(24) lgkmcnt(0)
  v_mfma_f32_32x32x16_bf16 v[160:175], v[144:147], v[48:51], v[160:175]
  ds_read_b64_tr_b16 v[152:153], v11 offset:2048
  ds_read_b64_tr_b16 v[154:155], v11 offset:3072
  ds_read_b64_tr_b16 v[156:157], v12 offset:2048
  ds_read_b64_tr_b16 v[158:159], v12 offset:3072
  v_mfma_f32_32x32x16_bf16 v[176:191], v[148:151], v[48:51], v[176:191]
  s_waitcnt vmcnt(23) lgkmcnt(0)
  v_mfma_f32_32x32x16_bf16 v[160:175], v[152:155], v[52:55], v[160:175]
  ds_read_b64_tr_b16 v[144:145], v11 offset:4096
  ds_read_b64_tr_b16 v[146:147], v11 offset:5120
  ds_read_b64_tr_b16 v[148:149], v12 offset:4096
  ds_read_b64_tr_b16 v[150:151], v12 offset:5120
  v_mfma_f32_32x32x16_bf16 v[176:191], v[156:159], v[52:55], v[176:191]
  s_waitcnt vmcnt(22) lgkmcnt(0)
  v_mfma_f32_32x32x16_bf16 v[160:175], v[144:147], v[56:59], v[160:175]
  ds_read_b64_tr_b16 v[152:153], v11 offset:6144
  ds_read_b64_tr_b16 v[154:155], v11 offset:7168
  ds_read_b64_tr_b16 v[156:157], v12 offset:6144
  ds_read_b64_tr_b16 v[158:159], v12 offset:7168
  v_mfma_f32_32x32x16_bf16 v[176:191], v[148:151], v[56:59], v[176:191]
  s_waitcnt vmcnt(21) lgkmcnt(0)
  v_mfma_f32_32x32x16_bf16 v[160:175], v[152:155], v[60:63], v[160:175]
  ds_read_b64_tr_b16 v[144:145], v11 offset:32768
  ds_read_b64_tr_b16 v[146:147], v11 offset:33792
  ds_read_b64_tr_b16 v[148:149], v12 offset:32768
  ds_read_b64_tr_b16 v[150:151], v12 offset:33792
  v_mfma_f32_32x32x16_bf16 v[176:191], v[156:159], v[60:63], v[176:191]
  s_waitcnt vmcnt(20) lgkmcnt(0)
  v_mfma_f32_32x32x16_bf16 v[160:175], v[144:147], v[64:67], v[160:175]
  ds_read_b64_tr_b16 v[152:153], v11 offset:34816
  ds_read_b64_tr_b16 v[154:155], v11 offset:35840
  ds_read_b64_tr_b16 v[156:157], v12 offset:34816
  ds_read_b64_tr_b16 v[158:159], v12 offset:35840
  v_mfma_f32_32x32x16_bf16 v[176:191], v[148:151], v[64:67], v[176:191]
  s_waitcnt vmcnt(19) lgkmcnt(0)
  v_mfma_f32_32x32x16_bf16 v[160:175], v[152:155], v[68:71], v[160:175]
  ds_read_b64_tr_b16 v[144:145], v11 offset:36864
  ds_read_b64_tr_b16 v[146:147], v11 offset:37888
  ds_read_b64_tr_b16 v[148:149], v12 offset:36864
  ds_read_b64_tr_b16 v[150:151], v12 offset:37888
  v_mfma_f32_32x32x16_bf16 v[176:191], v[156:159], v[68:71], v[176:191]
  s_waitcnt vmcnt(18) lgkmcnt(0)
  v_mfma_f32_32x32x16_bf16 v[160:175], v[144:147], v[72:75], v[160:175]
  ds_read_b64_tr_b16 v[152:153], v11 offset:38912
  ds_read_b64_tr_b16 v[154:155], v11 offset:39936
  ds_read_b64_tr_b16 v[156:157], v12 offset:38912
  ds_read_b64_tr_b16 v[158:159], v12 offset:39936
  v_mfma_f32_32x32x16_bf16 v[176:191], v[148:151], v[72:75], v[176:191]
  s_waitcnt vmcnt(17) lgkmcnt(0)
  v_mfma_f32_32x32x16_bf16 v[160:175], v[152:155], v[76:79], v[160:175]
  ds_read_b64_tr_b16 v[144:145], v11 offset:8192
  ds_read_b64_tr_b16 v[146:147], v11 offset:9216
  ds_read_b64_tr_b16 v[148:149], v12 offset:8192
  ds_read_b64_tr_b16 v[150:151], v12 offset:9216
  v_mfma_f32_32x32x16_bf16 v[176:191], v[156:159], v[76:79], v[176:191]
  s_waitcnt vmcnt(16) lgkmcnt(0)
  v_mfma_f32_32x32x16_bf16 v[160:175], v[144:147], v[80:83], v[160:175]
  ds_read_b64_tr_b16 v[152:153], v11 offset:10240
  ds_read_b64_tr_b16 v[154:155], v11 offset:11264
  ds_read_b64_tr_b16 v[156:157], v12 offset:10240
  ds_read_b64_tr_b16 v[158:159], v12 offset:11264
  v_mfma_f32_32x32x16_bf16 v[176:191], v[148:151], v[80:83], v[176:191]
  s_waitcnt vmcnt(15) lgkmcnt(0)
  v_mfma_f32_32x32x16_bf16 v[160:175], v[152:155], v[84:87], v[160:175]
  ds_read_b64_tr_b16 v[144:145], v11 offset:12288
  ds_read_b64_tr_b16 v[146:147], v11 offset:13312
  ds_read_b64_tr_b16 v[148:149], v12 offset:12288
  ds_read_b64_tr_b16 v[150:151], v12 offset:13312
  v_mfma_f32_32x32x16_bf16 v[176:191], v[156:159], v[84:87], v[176:191]
  s_waitcnt vmcnt(14) lgkmcnt(0)
  v_mfma_f32_32x32x16_bf16 v[160:175], v[144:147], v[88:91], v[160:175]
  ds_read_b64_tr_b16 v[152:153], v11 offset:14336
  ds_read_b64_tr_b16 v[154:155], v11 offset:15360
  ds_read_b64_tr_b16 v[156:157], v12 offset:14336
  ds_read_b64_tr_b16 v[158:159], v12 offset:15360
  v_mfma_f32_32x32x16_bf16 v[176:191], v[148:151], v[88:91], v[176:191]
  s_waitcnt vmcnt(13) lgkmcnt(0)
  v_mfma_f32_32x32x16_bf16 v[160:175], v[152:155], v[92:95], v[160:175]
  ds_read_b64_tr_b16 v[144:145], v11 offset:40960
  ds_read_b64_tr_b16 v[146:147], v11 offset:41984
  ds_read_b64_tr_b16 v[148:149], v12 offset:40960
  ds_read_b64_tr_b16 v[150:151], v12 offset:41984
  v_mfma_f32_32x32x16_bf16 v[176:191], v[156:159], v[92:95], v[176:191]
  s_waitcnt vmcnt(12) lgkmcnt(0)
  v_mfma_f32_32x32x16_bf16 v[160:175], v[144:147], v[96:99], v[160:175]
  ds_read_b64_tr_b16 v[152:153], v11 offset:43008
  ds_read_b64_tr_b16 v[154:155], v11 offset:44032
  ds_read_b64_tr_b16 v[156:157], v12 offset:43008
  ds_read_b64_tr_b16 v[158:159], v12 offset:44032
  v_mfma_f32_32x32x16_bf16 v[176:191], v[148:151], v[96:99], v[176:191]
  s_waitcnt vmcnt(11) lgkmcnt(0)
  v_mfma_f32_32x32x16_bf16 v[160:175], v[152:155], v[100:103], v[160:175]
  ds_read_b64_tr_b16 v[144:145], v11 offset:45056
  ds_read_b64_tr_b16 v[146:147], v11 offset:46080
  ds_read_b64_tr_b16 v[148:149], v12 offset:45056
  ds_read_b64_tr_b16 v[150:151], v12 offset:46080
  v_mfma_f32_32x32x16_bf16 v[176:191], v[156:159], v[100:103], v[176:191]
  s_waitcnt vmcnt(10) lgkmcnt(0)
  v_mfma_f32_32x32x16_bf16 v[160:175], v[144:147], v[104:107], v[160:175]
  ds_read_b64_tr_b16 v[152:153], v11 offset:47104
  ds_read_b64_tr_b16 v[154:155], v11 offset:48128
  ds_read_b64_tr_b16 v[156:157], v12 offset:47104
  ds_read_b64_tr_b16 v[158:159], v12 offset:48128
  v_mfma_f32_32x32x16_bf16 v[176:191], v[148:151], v[104:107], v[176:191]
  s_waitcnt vmcnt(9) lgkmcnt(0)
  v_mfma_f32_32x32x16_bf16 v[160:175], v[152:155], v[108:111], v[160:175]
  ds_read_b64_tr_b16 v[144:145], v11 offset:16384
  ds_read_b64_tr_b16 v[146:147], v11 offset:17408
  ds_read_b64_tr_b16 v[148:149], v12 offset:16384
  ds_read_b64_tr_b16 v[150:151], v12 offset:17408
  v_mfma_f32_32x32x16_bf16 v[176:191], v[156:159], v[108:111], v[176:191]
  s_waitcnt vmcnt(8) lgkmcnt(0)
  v_mfma_f32_32x32x16_bf16 v[160:175], v[144:147], v[112:115], v[160:175]
  ds_read_b64_tr_b16 v[152:153], v11 offset:18432
  ds_read_b64_tr_b16 v[154:155], v11 offset:19456
  ds_read_b64_tr_b16 v[156:157], v12 offset:18432
  ds_read_b64_tr_b16 v[158:159], v12 offset:19456
  v_mfma_f32_32x32x16_bf16 v[176:191], v[148:151], v[112:115], v[176:191]
  s_waitcnt vmcnt(7) lgkmcnt(0)
  v_mfma_f32_32x32x16_bf16 v[160:175], v[152:155], v[116:119], v[160:175]
  ds_read_b64_tr_b16 v[144:145], v11 offset:20480
  ds_read_b64_tr_b16 v[146:147], v11 offset:21504
  ds_read_b64_tr_b16 v[148:149], v12 offset:20480
  ds_read_b64_tr_b16 v[150:151], v12 offset:21504
  v_mfma_f32_32x32x16_bf16 v[176:191], v[156:159], v[116:119], v[176:191]
  s_waitcnt vmcnt(6) lgkmcnt(0)
  v_mfma_f32_32x32x16_bf16 v[160:175], v[144:147], v[120:123], v[160:175]
  ds_read_b64_tr_b16 v[152:153], v11 offset:22528
  ds_read_b64_tr_b16 v[154:155], v11 offset:23552
  ds_read_b64_tr_b16 v[156:157], v12 offset:22528
  ds_read_b64_tr_b16 v[158:159], v12 offset:23552
  v_mfma_f32_32x32x16_bf16 v[176:191], v[148:151], v[120:123], v[176:191]
  s_waitcnt vmcnt(5) lgkmcnt(0)
  v_mfma_f32_32x32x16_bf16 v[160:175], v[152:155], v[124:127], v[160:175]
  ds_read_b64_tr_b16 v[144:145], v11 offset:49152
  ds_read_b64_tr_b16 v[146:147], v11 offset:50176
  ds_read_b64_tr_b16 v[148:149], v12 offset:49152
  ds_read_b64_tr_b16 v[150:151], v12 offset:50176
  v_mfma_f32_32x32x16_bf16 v[176:191], v[156:159], v[124:127], v[176:191]
  s_waitcnt vmcnt(4) lgkmcnt(0)
  v_mfma_f32_32x32x16_bf16 v[160:175], v[144:147], v[128:131], v[160:175]
  ds_read_b64_tr_b16 v[152:153], v11 offset:51200
  ds_read_b64_tr_b16 v[154:155], v11 offset:52224
  ds_read_b64_tr_b16 v[156:157], v12 offset:51200
  ds_read_b64_tr_b16 v[158:159], v12 offset:52224
  v_mfma_f32_32x32x16_bf16 v[176:191], v[148:151], v[128:131], v[176:191]
  s_waitcnt vmcnt(3) lgkmcnt(0)
  v_mfma_f32_32x32x16_bf16 v[160:175], v[152:155], v[132:135], v[160:175]
  ds_read_b64_tr_b16 v[144:145], v11 offset:53248
  ds_read_b64_tr_b16 v[146:147], v11 offset:54272
  ds_read_b64_tr_b16 v[148:149], v12 offset:53248
  ds_read_b64_tr_b16 v[150:151], v12 offset:54272
  v_mfma_f32_32x32x16_bf16 v[176:191], v[156:159], v[132:135], v[176:191]
  s_waitcnt vmcnt(2) lgkmcnt(0)
  v_mfma_f32_32x32x16_bf16 v[160:175], v[144:147], v[136:139], v[160:175]
  ds_read_b64_tr_b16 v[152:153], v11 offset:55296
  ds_read_b64_tr_b16 v[154:155], v11 offset:56320
  ds_read_b64_tr_b16 v[156:157], v12 offset:55296
  ds_read_b64_tr_b16 v[158:159], v12 offset:56320
  v_mfma_f32_32x32x16_bf16 v[176:191], v[148:151], v[136:139], v[176:191]
  s_waitcnt vmcnt(1) lgkmcnt(0)
  v_mfma_f32_32x32x16_bf16 v[160:175], v[152:155], v[140:143], v[160:175]
  v_mfma_f32_32x32x16_bf16 v[176:191], v[156:159], v[140:143], v[176:191]
  s_waitcnt vmcnt(0)
  v_sub_f32 v4, 1.0, v6
  s_cmp_eq_u32 s43, 0
  s_cbranch_scc1 gated_mix__mha_block__mha_block__prompt_kernel_rd
  s_nop 12
  v_mul_f32 v160, v4, v160
  v_mul_f32 v161, v4, v161
  v_mul_f32 v162, v4, v162
  v_mul_f32 v163, v4, v163
  v_mul_f32 v164, v4, v164
  v_mul_f32 v165, v4, v165
  v_mul_f32 v166, v4, v166
  v_mul_f32 v167, v4, v167
  v_mul_f32 v168, v4, v168
  v_mul_f32 v169, v4, v169
  v_mul_f32 v170, v4, v170
  v_mul_f32 v171, v4, v171
  v_mul_f32 v172, v4, v172
  v_mul_f32 v173, v4, v173
  v_mul_f32 v174, v4, v174
  v_mul_f32 v175, v4, v175
  v_mul_f32 v176, v4, v176
  v_mul_f32 v177, v4, v177
  v_mul_f32 v178, v4, v178
  v_mul_f32 v179, v4, v179
  v_mul_f32 v180, v4, v180
  v_mul_f32 v181, v4, v181
  v_mul_f32 v182, v4, v182
  v_mul_f32 v183, v4, v183
  v_mul_f32 v184, v4, v184
  v_mul_f32 v185, v4, v185
  v_mul_f32 v186, v4, v186
  v_mul_f32 v187, v4, v187
  v_mul_f32 v188, v4, v188
  v_mul_f32 v189, v4, v189
  v_mul_f32 v190, v4, v190
  v_mul_f32 v191, v4, v191
  ds_write_b128 v10, v[160:163] offset:0
  ds_write_b128 v10, v[164:167] offset:1024
  ds_write_b128 v10, v[168:171] offset:2048
  ds_write_b128 v10, v[172:175] offset:3072
  ds_write_b128 v10, v[176:179] offset:4096
  ds_write_b128 v10, v[180:183] offset:5120
  ds_write_b128 v10, v[184:187] offset:6144
  ds_write_b128 v10, v[188:191] offset:7168
  s_waitcnt lgkmcnt(0)
  s_barrier
  s_branch gated_mix__mha_block__mha_block__prompt_kernel_done
gated_mix__mha_block__mha_block__prompt_kernel_rd:
  s_barrier
  ds_read_b128 v[16:19], v10 offset:0
  ds_read_b128 v[20:23], v10 offset:1024
  ds_read_b128 v[24:27], v10 offset:2048
  ds_read_b128 v[28:31], v10 offset:3072
  ds_read_b128 v[32:35], v10 offset:4096
  ds_read_b128 v[36:39], v10 offset:5120
  ds_read_b128 v[40:43], v10 offset:6144
  ds_read_b128 v[44:47], v10 offset:7168
  s_waitcnt lgkmcnt(6)
  v_fmac_f32 v16, v6, v160
  v_fmac_f32 v17, v6, v161
  v_fmac_f32 v18, v6, v162
  v_fmac_f32 v19, v6, v163
  v_fmac_f32 v20, v6, v164
  v_fmac_f32 v21, v6, v165
  v_fmac_f32 v22, v6, v166
  v_fmac_f32 v23, v6, v167
  v_cvt_pk_bf16_f32 v192, v16, v17
  v_cvt_pk_bf16_f32 v193, v18, v19
  v_cvt_pk_bf16_f32 v194, v20, v21
  v_cvt_pk_bf16_f32 v195, v22, v23
  s_waitcnt lgkmcnt(4)
  v_fmac_f32 v24, v6, v168
  v_fmac_f32 v25, v6, v169
  v_fmac_f32 v26, v6, v170
  v_fmac_f32 v27, v6, v171
  v_fmac_f32 v28, v6, v172
  v_fmac_f32 v29, v6, v173
  v_fmac_f32 v30, v6, v174
  v_fmac_f32 v31, v6, v175
  v_cvt_pk_bf16_f32 v196, v24, v25
  v_cvt_pk_bf16_f32 v197, v26, v27
  v_cvt_pk_bf16_f32 v198, v28, v29
  v_cvt_pk_bf16_f32 v199, v30, v31
  s_waitcnt lgkmcnt(2)
  v_fmac_f32 v32, v6, v176
  v_fmac_f32 v33, v6, v177
  v_fmac_f32 v34, v6, v178
  v_fmac_f32 v35, v6, v179
  v_fmac_f32 v36, v6, v180
  v_fmac_f32 v37, v6, v181
  v_fmac_f32 v38, v6, v182
  v_fmac_f32 v39, v6, v183
  v_cvt_pk_bf16_f32 v200, v32, v33
  v_cvt_pk_bf16_f32 v201, v34, v35
  v_cvt_pk_bf16_f32 v202, v36, v37
  v_cvt_pk_bf16_f32 v203, v38, v39
  s_waitcnt lgkmcnt(0)
  v_fmac_f32 v40, v6, v184
  v_fmac_f32 v41, v6, v185
  v_fmac_f32 v42, v6, v186
  v_fmac_f32 v43, v6, v187
  v_fmac_f32 v44, v6, v188
  v_fmac_f32 v45, v6, v189
  v_fmac_f32 v46, v6, v190
  v_fmac_f32 v47, v6, v191
  v_cvt_pk_bf16_f32 v204, v40, v41
  v_cvt_pk_bf16_f32 v205, v42, v43
  v_cvt_pk_bf16_f32 v206, v44, v45
  v_cvt_pk_bf16_f32 v207, v46, v47
  s_nop 1
  v_permlane32_swap_b32 v192, v194
  v_permlane32_swap_b32 v193, v195
  v_permlane32_swap_b32 v196, v198
  v_permlane32_swap_b32 v197, v199
  v_permlane32_swap_b32 v200, v202
  v_permlane32_swap_b32 v201, v203
  v_permlane32_swap_b32 v204, v206
  v_permlane32_swap_b32 v205, v207
  buffer_store_dwordx4 v[192:195], v9, s[8:11], s48 offen offset:0
  buffer_store_dwordx4 v[196:199], v9, s[8:11], s48 offen offset:32
  buffer_store_dwordx4 v[200:203], v9, s[8:11], s48 offen offset:64
  buffer_store_dwordx4 v[204:207], v9, s[8:11], s48 offen offset:96
gated_mix__mha_block__mha_block__prompt_kernel_done:
gated_mix__mha_block__mha_block__prompt_kernel_end:
  s_endpgm
.section .rodata,"a"
.p2align 6
.amdhsa_kernel gated_mix__mha_block__mha_block__prompt_kernel
  .amdhsa_next_free_vgpr 252
  .amdhsa_next_free_sgpr 102
  .amdhsa_accum_offset 252
  .amdhsa_group_segment_fixed_size 0
  .amdhsa_kernarg_size 80
  .amdhsa_user_sgpr_count 2
  .amdhsa_user_sgpr_kernarg_segment_ptr 1
  .amdhsa_system_sgpr_workgroup_id_x 1
.end_amdhsa_kernel
```
